```python
import torch

def _softmax(x, axis=-1):
    return torch.softmax(x, dim=axis)
def _gelu(x):
    return torch.nn.functional.gelu(x, approximate="tanh")
def _silu(x):
    return torch.nn.functional.silu(x)
def _sigmoid(x):
    return torch.sigmoid(x)
def _layernorm(x, axis=-1, eps=1e-5):
    m = x.mean(dim=axis, keepdim=True)
    v = x.var(dim=axis, keepdim=True, unbiased=False)
    return (x - m) / torch.sqrt(v + eps)
def _scatter_add(tgt, idx, src, axis=0):
    return tgt.clone().index_add_(axis, idx, src)
def _segment_sum(src, seg, n):
    out = torch.zeros((n,) + src.shape[1:], dtype=src.dtype)
    return out.index_add_(0, seg, src)
def _pad(x, pw):
    flat = tuple(v for pair in reversed(pw) for v in pair)
    return torch.nn.functional.pad(x, flat)

kernel_name = 'standalone__mha_softmax__near_ridge'

def setup_inputs():

    _w = (lambda a: (lambda t: t.to(torch.bfloat16) if t.is_floating_point() else t)(torch.as_tensor(a)))
    B, H, Sq, Sk, D = 16, 32, 192, 1024, 128
    return {
        "q": _w((lambda *s: torch.randn(*s, dtype=torch.bfloat16) * 0.8)(B, H, Sq, D)),
        "k": _w((lambda *s: torch.randn(*s, dtype=torch.bfloat16) * 0.8)(B, H, Sk, D)),
        "v": _w((lambda *s: torch.randn(*s, dtype=torch.bfloat16) * 0.05)(B, H, Sk, D)),
    }

def reference(q, k, v):
    scale = q.shape[-1] ** -0.5
    scores = torch.einsum("bhqd,bhkd->bhqk", q, k) * scale
    p = _softmax(scores, axis=-1)
    return torch.einsum("bhqk,bhkd->bhqd", p, v)
```

```asm
; @launch grid=(512,1,1) block=(128,1,1) lds=50688
.amdgcn_target "amdgcn-amd-amdhsa--gfx950"
.text
.globl standalone__mha_softmax__near_ridge_kernel
.p2align 8
.type standalone__mha_softmax__near_ridge_kernel,@function
standalone__mha_softmax__near_ridge_kernel:
s_cmp_ge_u32 s2, 512
s_cbranch_scc1 L_end
s_load_dwordx4 s[4:7], s[0:1], 0
s_load_dwordx4 s[8:11], s[0:1], 16
v_lshrrev_b32 v1, 6, v0
v_and_b32 v0, 63, v0
v_readfirstlane_b32 s3, v1
v_and_b32 v9, 15, v0
v_lshrrev_b32 v10, 4, v0
v_lshlrev_b32 v7, 8, v9
v_lshl_add_u32 v7, v10, 4, v7
v_and_b32 v11, 7, v0
v_mul_u32_u24 v1, 1056, v11
v_bfe_u32 v11, v0, 3, 1
v_lshl_add_u32 v1, v11, 8, v1
v_lshl_add_u32 v1, v10, 4, v1
v_bfe_u32 v11, v0, 2, 3
v_mul_u32_u24 v2, 1056, v11
v_lshrrev_b32 v11, 5, v0
v_lshl_add_u32 v2, v11, 8, v2
v_and_b32 v11, 3, v0
v_lshl_add_u32 v2, v11, 3, v2
v_lshlrev_b32 v3, 4, v0
s_mov_b32 s32, s2
s_mul_i32 s33, s32, 49152
s_mul_i32 s34, s3, 24576
s_add_u32 s33, s33, s34
s_lshl_b32 s36, s32, 18
s_lshl_b32 s37, s3, 12
v_add_u32 v3, s37, v3
s_mul_i32 s40, s3, 4224
s_mov_b32 s50, 0x3e0293ee
s_mov_b32 s51, s50
s_waitcnt lgkmcnt(0)
s_add_u32 s12, s4, s33
s_addc_u32 s13, s5, 0
s_mov_b32 s14, 24576
s_mov_b32 s15, 0x20000
s_add_u32 s16, s6, s36
s_addc_u32 s17, s7, 0
s_mov_b32 s18, 262144
s_mov_b32 s19, 0x20000
s_add_u32 s20, s8, s36
s_addc_u32 s21, s9, 0
s_mov_b32 s22, 262144
s_mov_b32 s23, 0x20000
s_mov_b32 s43, s40
s_add_u32 s42, s40, 50688
s_lshr_b32 s38, s2, 8
s_and_b32 s38, s38, 1
s_add_u32 m0, s43, 8448
s_nop 0
buffer_load_dwordx4 v3, s[16:19], 0 offen offset:0 nt lds
s_add_u32 m0, m0, 32
s_nop 0
buffer_load_dwordx4 v3, s[16:19], 0 offen offset:1024 nt lds
s_add_u32 m0, m0, 32
s_nop 0
buffer_load_dwordx4 v3, s[16:19], 0 offen offset:2048 nt lds
s_add_u32 m0, m0, 32
s_nop 0
buffer_load_dwordx4 v3, s[16:19], 0 offen offset:3072 nt lds
s_mov_b32 m0, s43
s_nop 0
buffer_load_dwordx4 v3, s[20:23], 0 offen offset:0 nt lds
s_add_u32 m0, m0, 32
s_nop 0
buffer_load_dwordx4 v3, s[20:23], 0 offen offset:1024 nt lds
s_add_u32 m0, m0, 32
s_nop 0
buffer_load_dwordx4 v3, s[20:23], 0 offen offset:2048 nt lds
s_add_u32 m0, m0, 32
s_nop 0
buffer_load_dwordx4 v3, s[20:23], 0 offen offset:3072 nt lds
v_add_u32 v3, 0x2000, v3
s_add_u32 s43, s43, 16896
s_cmp_ge_u32 s43, s42
s_cselect_b32 s43, s40, s43
s_cmp_eq_u32 s38, 0
s_cbranch_scc1 L_w1
s_waitcnt vmcnt(0)
L_w1:
buffer_load_dwordx4 v[64:67], v7, s[12:15], 0 offen offset:0 nt
buffer_load_dwordx4 v[68:71], v7, s[12:15], 0 offen offset:64 nt
buffer_load_dwordx4 v[72:75], v7, s[12:15], 0 offen offset:128 nt
buffer_load_dwordx4 v[76:79], v7, s[12:15], 0 offen offset:192 nt
s_movk_i32 s35, 4096
buffer_load_dwordx4 v[80:83], v7, s[12:15], s35 offen offset:0 nt
buffer_load_dwordx4 v[84:87], v7, s[12:15], s35 offen offset:64 nt
buffer_load_dwordx4 v[88:91], v7, s[12:15], s35 offen offset:128 nt
buffer_load_dwordx4 v[92:95], v7, s[12:15], s35 offen offset:192 nt
s_add_u32 s24, s10, s33
s_addc_u32 s25, s11, 0
s_mov_b32 s26, 24576
s_mov_b32 s27, 0x20000
s_cmp_eq_u32 s38, 0
s_mov_b32 s54, 0x18000000
s_mov_b32 s55, 0x1fffffff
s_mov_b32 s56, 0x30000000
v_mov_b32 v160, 0
v_mov_b32 v161, 0
v_mov_b32 v162, 0
v_mov_b32 v163, 0
v_mov_b32 v164, 0
v_mov_b32 v165, 0
v_mov_b32 v166, 0
v_mov_b32 v167, 0
v_mov_b32 v168, 0
v_mov_b32 v169, 0
v_mov_b32 v170, 0
v_mov_b32 v171, 0
v_mov_b32 v172, 0
v_mov_b32 v173, 0
v_mov_b32 v174, 0
v_mov_b32 v175, 0
v_mov_b32 v176, 0
v_mov_b32 v177, 0
v_mov_b32 v178, 0
v_mov_b32 v179, 0
v_mov_b32 v180, 0
v_mov_b32 v181, 0
v_mov_b32 v182, 0
v_mov_b32 v183, 0
v_mov_b32 v184, 0
v_mov_b32 v185, 0
v_mov_b32 v186, 0
v_mov_b32 v187, 0
v_mov_b32 v188, 0
v_mov_b32 v189, 0
v_mov_b32 v190, 0
v_mov_b32 v191, 0
v_mov_b32 v192, 0
v_mov_b32 v193, 0
v_mov_b32 v194, 0
v_mov_b32 v195, 0
v_mov_b32 v196, 0
v_mov_b32 v197, 0
v_mov_b32 v198, 0
v_mov_b32 v199, 0
v_mov_b32 v200, 0
v_mov_b32 v201, 0
v_mov_b32 v202, 0
v_mov_b32 v203, 0
v_mov_b32 v204, 0
v_mov_b32 v205, 0
v_mov_b32 v206, 0
v_mov_b32 v207, 0
v_mov_b32 v208, 0
v_mov_b32 v209, 0
v_mov_b32 v210, 0
v_mov_b32 v211, 0
v_mov_b32 v212, 0
v_mov_b32 v213, 0
v_mov_b32 v214, 0
v_mov_b32 v215, 0
v_mov_b32 v216, 0
v_mov_b32 v217, 0
v_mov_b32 v218, 0
v_mov_b32 v219, 0
v_mov_b32 v220, 0
v_mov_b32 v221, 0
v_mov_b32 v222, 0
v_mov_b32 v223, 0
v_mov_b32 v224, 0
v_mov_b32 v225, 0
v_mov_b32 v226, 0
v_mov_b32 v227, 0
v_mov_b32 v228, 0
v_mov_b32 v229, 0
v_mov_b32 v230, 0
v_mov_b32 v231, 0
v_mov_b32 v232, 0
v_mov_b32 v233, 0
v_mov_b32 v234, 0
v_mov_b32 v235, 0
v_mov_b32 v236, 0
v_mov_b32 v237, 0
v_mov_b32 v238, 0
v_mov_b32 v239, 0
v_mov_b32 v240, 0
v_mov_b32 v241, 0
v_mov_b32 v242, 0
v_mov_b32 v243, 0
v_mov_b32 v244, 0
v_mov_b32 v245, 0
v_mov_b32 v246, 0
v_mov_b32 v247, 0
v_mov_b32 v248, 0
v_mov_b32 v249, 0
v_mov_b32 v250, 0
v_mov_b32 v251, 0
v_mov_b32 v252, 0
v_mov_b32 v253, 0
v_mov_b32 v254, 0
v_mov_b32 v255, 0
v_accvgpr_write_b32 a128, 0
v_accvgpr_write_b32 a129, 0
v_accvgpr_write_b32 a130, 0
v_accvgpr_write_b32 a131, 0
v_accvgpr_write_b32 a132, 0
v_accvgpr_write_b32 a133, 0
v_accvgpr_write_b32 a134, 0
v_accvgpr_write_b32 a135, 0
v_accvgpr_write_b32 a136, 0
v_accvgpr_write_b32 a137, 0
v_accvgpr_write_b32 a138, 0
v_accvgpr_write_b32 a139, 0
v_accvgpr_write_b32 a140, 0
v_accvgpr_write_b32 a141, 0
v_accvgpr_write_b32 a142, 0
v_accvgpr_write_b32 a143, 0
v_accvgpr_write_b32 a144, 0
v_accvgpr_write_b32 a145, 0
v_accvgpr_write_b32 a146, 0
v_accvgpr_write_b32 a147, 0
v_accvgpr_write_b32 a148, 0
v_accvgpr_write_b32 a149, 0
v_accvgpr_write_b32 a150, 0
v_accvgpr_write_b32 a151, 0
v_accvgpr_write_b32 a152, 0
v_accvgpr_write_b32 a153, 0
v_accvgpr_write_b32 a154, 0
v_accvgpr_write_b32 a155, 0
v_accvgpr_write_b32 a156, 0
v_accvgpr_write_b32 a157, 0
v_accvgpr_write_b32 a158, 0
v_accvgpr_write_b32 a159, 0
v_accvgpr_write_b32 a164, 0
v_accvgpr_write_b32 a165, 0
v_accvgpr_write_b32 a166, 0
v_accvgpr_write_b32 a167, 0
v_accvgpr_write_b32 a168, 0
v_accvgpr_write_b32 a169, 0
v_accvgpr_write_b32 a170, 0
v_accvgpr_write_b32 a171, 0
v_accvgpr_write_b32 a172, 0
v_accvgpr_write_b32 a173, 0
v_accvgpr_write_b32 a174, 0
v_accvgpr_write_b32 a175, 0
v_accvgpr_write_b32 a176, 0
v_accvgpr_write_b32 a177, 0
v_accvgpr_write_b32 a178, 0
v_accvgpr_write_b32 a179, 0
v_accvgpr_write_b32 a180, 0
v_accvgpr_write_b32 a181, 0
v_accvgpr_write_b32 a182, 0
v_accvgpr_write_b32 a183, 0
v_accvgpr_write_b32 a184, 0
v_accvgpr_write_b32 a185, 0
v_accvgpr_write_b32 a186, 0
v_accvgpr_write_b32 a187, 0
v_cmp_eq_u32 vcc, 0, v9
v_mov_b32 v4, 0x3f803f80
s_mov_b32 s44, 0
v_cndmask_b32 v4, 0, v4, vcc
s_mov_b32 s45, 0
s_mov_b32 s49, 0xffff0000
v_accvgpr_write_b32 a160, v4
v_accvgpr_write_b32 a161, v4
v_accvgpr_write_b32 a162, v4
v_accvgpr_write_b32 a163, v4
s_waitcnt vmcnt(8)
s_barrier
ds_read_b128 a[96:99], v1 offset:8448
ds_read_b128 a[100:103], v1 offset:8512
ds_read_b128 a[104:107], v1 offset:8576
ds_read_b128 a[108:111], v1 offset:8640
ds_read_b128 a[112:115], v1 offset:8960
ds_read_b128 a[116:119], v1 offset:9024
ds_read_b128 a[120:123], v1 offset:9088
ds_read_b128 a[124:127], v1 offset:9152
s_waitcnt vmcnt(7)
s_movk_i32 s35, 8192
buffer_load_dwordx4 v[96:99], v7, s[12:15], s35 offen offset:0 nt
v_lshlrev_b32 v16, 16, v64
v_and_b32 v17, s49, v64
v_lshlrev_b32 v18, 16, v65
v_and_b32 v19, s49, v65
v_lshlrev_b32 v20, 16, v66
v_and_b32 v21, s49, v66
v_lshlrev_b32 v22, 16, v67
v_and_b32 v23, s49, v67
v_pk_mul_f32 v[16:17], v[16:17], s[50:51]
v_pk_mul_f32 v[18:19], v[18:19], s[50:51]
v_pk_mul_f32 v[20:21], v[20:21], s[50:51]
v_pk_mul_f32 v[22:23], v[22:23], s[50:51]
v_cvt_pk_bf16_f32 v16, v16, v17
v_cvt_pk_bf16_f32 v18, v18, v19
v_cvt_pk_bf16_f32 v20, v20, v21
v_cvt_pk_bf16_f32 v22, v22, v23
v_accvgpr_write_b32 a0, v16
v_mov_b32 v64, 0
v_accvgpr_write_b32 a1, v18
v_mov_b32 v65, 0
v_accvgpr_write_b32 a2, v20
v_mov_b32 v66, 0
v_accvgpr_write_b32 a3, v22
v_mov_b32 v67, 0
s_waitcnt vmcnt(7)
buffer_load_dwordx4 v[100:103], v7, s[12:15], s35 offen offset:64 nt
v_lshlrev_b32 v16, 16, v68
v_and_b32 v17, s49, v68
v_lshlrev_b32 v18, 16, v69
v_and_b32 v19, s49, v69
v_lshlrev_b32 v20, 16, v70
v_and_b32 v21, s49, v70
v_lshlrev_b32 v22, 16, v71
v_and_b32 v23, s49, v71
v_pk_mul_f32 v[16:17], v[16:17], s[50:51]
v_pk_mul_f32 v[18:19], v[18:19], s[50:51]
v_pk_mul_f32 v[20:21], v[20:21], s[50:51]
v_pk_mul_f32 v[22:23], v[22:23], s[50:51]
v_cvt_pk_bf16_f32 v16, v16, v17
v_cvt_pk_bf16_f32 v18, v18, v19
v_cvt_pk_bf16_f32 v20, v20, v21
v_cvt_pk_bf16_f32 v22, v22, v23
v_accvgpr_write_b32 a4, v16
v_mov_b32 v68, 0
v_accvgpr_write_b32 a5, v18
v_mov_b32 v69, 0
v_accvgpr_write_b32 a6, v20
v_mov_b32 v70, 0
v_accvgpr_write_b32 a7, v22
v_mov_b32 v71, 0
s_waitcnt vmcnt(7)
buffer_load_dwordx4 v[104:107], v7, s[12:15], s35 offen offset:128 nt
v_lshlrev_b32 v16, 16, v72
v_and_b32 v17, s49, v72
v_lshlrev_b32 v18, 16, v73
v_and_b32 v19, s49, v73
v_lshlrev_b32 v20, 16, v74
v_and_b32 v21, s49, v74
v_lshlrev_b32 v22, 16, v75
v_and_b32 v23, s49, v75
v_pk_mul_f32 v[16:17], v[16:17], s[50:51]
v_pk_mul_f32 v[18:19], v[18:19], s[50:51]
v_pk_mul_f32 v[20:21], v[20:21], s[50:51]
v_pk_mul_f32 v[22:23], v[22:23], s[50:51]
v_cvt_pk_bf16_f32 v16, v16, v17
v_cvt_pk_bf16_f32 v18, v18, v19
v_cvt_pk_bf16_f32 v20, v20, v21
v_cvt_pk_bf16_f32 v22, v22, v23
v_accvgpr_write_b32 a8, v16
v_mov_b32 v72, 0
v_accvgpr_write_b32 a9, v18
v_mov_b32 v73, 0
v_accvgpr_write_b32 a10, v20
v_mov_b32 v74, 0
v_accvgpr_write_b32 a11, v22
v_mov_b32 v75, 0
s_waitcnt vmcnt(7)
buffer_load_dwordx4 v[108:111], v7, s[12:15], s35 offen offset:192 nt
v_lshlrev_b32 v16, 16, v76
v_and_b32 v17, s49, v76
v_lshlrev_b32 v18, 16, v77
v_and_b32 v19, s49, v77
v_lshlrev_b32 v20, 16, v78
v_and_b32 v21, s49, v78
v_lshlrev_b32 v22, 16, v79
v_and_b32 v23, s49, v79
v_pk_mul_f32 v[16:17], v[16:17], s[50:51]
v_pk_mul_f32 v[18:19], v[18:19], s[50:51]
v_pk_mul_f32 v[20:21], v[20:21], s[50:51]
v_pk_mul_f32 v[22:23], v[22:23], s[50:51]
v_cvt_pk_bf16_f32 v16, v16, v17
v_cvt_pk_bf16_f32 v18, v18, v19
v_cvt_pk_bf16_f32 v20, v20, v21
v_cvt_pk_bf16_f32 v22, v22, v23
v_accvgpr_write_b32 a12, v16
v_mov_b32 v76, 0
v_accvgpr_write_b32 a13, v18
v_mov_b32 v77, 0
v_accvgpr_write_b32 a14, v20
v_mov_b32 v78, 0
v_accvgpr_write_b32 a15, v22
v_mov_b32 v79, 0
s_waitcnt lgkmcnt(0)
v_mfma_f32_16x16x32_bf16 v[8:11], a[96:99], a[0:3], 0
v_mfma_f32_16x16x32_bf16 v[8:11], a[100:103], a[4:7], v[8:11]
v_mfma_f32_16x16x32_bf16 v[8:11], a[104:107], a[8:11], v[8:11]
v_mfma_f32_16x16x32_bf16 v[8:11], a[108:111], a[12:15], v[8:11]
v_mfma_f32_16x16x32_bf16 v[12:15], a[112:115], a[0:3], 0
v_mfma_f32_16x16x32_bf16 v[12:15], a[116:119], a[4:7], v[12:15]
v_mfma_f32_16x16x32_bf16 v[12:15], a[120:123], a[8:11], v[12:15]
v_mfma_f32_16x16x32_bf16 v[12:15], a[124:127], a[12:15], v[12:15]
s_waitcnt vmcnt(7)
s_movk_i32 s35, 12288
buffer_load_dwordx4 v[112:115], v7, s[12:15], s35 offen offset:0 nt
v_lshlrev_b32 v16, 16, v80
v_and_b32 v17, s49, v80
v_lshlrev_b32 v18, 16, v81
v_and_b32 v19, s49, v81
v_lshlrev_b32 v20, 16, v82
v_and_b32 v21, s49, v82
v_lshlrev_b32 v22, 16, v83
v_and_b32 v23, s49, v83
v_pk_mul_f32 v[16:17], v[16:17], s[50:51]
v_pk_mul_f32 v[18:19], v[18:19], s[50:51]
v_pk_mul_f32 v[20:21], v[20:21], s[50:51]
v_pk_mul_f32 v[22:23], v[22:23], s[50:51]
v_cvt_pk_bf16_f32 v16, v16, v17
v_cvt_pk_bf16_f32 v18, v18, v19
v_cvt_pk_bf16_f32 v20, v20, v21
v_cvt_pk_bf16_f32 v22, v22, v23
v_accvgpr_write_b32 a16, v16
v_mov_b32 v80, 0
v_accvgpr_write_b32 a17, v18
v_mov_b32 v81, 0
v_accvgpr_write_b32 a18, v20
v_mov_b32 v82, 0
v_accvgpr_write_b32 a19, v22
v_mov_b32 v83, 0
v_max3_f32 v56, v8, v9, v10
v_max3_f32 v56, v56, v11, v12
v_max3_f32 v56, v56, v13, v14
v_max_f32 v56, v56, v15
s_waitcnt vmcnt(7)
buffer_load_dwordx4 v[116:119], v7, s[12:15], s35 offen offset:64 nt
v_lshlrev_b32 v16, 16, v84
v_and_b32 v17, s49, v84
v_lshlrev_b32 v18, 16, v85
v_and_b32 v19, s49, v85
v_lshlrev_b32 v20, 16, v86
v_and_b32 v21, s49, v86
v_lshlrev_b32 v22, 16, v87
v_and_b32 v23, s49, v87
v_pk_mul_f32 v[16:17], v[16:17], s[50:51]
v_pk_mul_f32 v[18:19], v[18:19], s[50:51]
v_pk_mul_f32 v[20:21], v[20:21], s[50:51]
v_pk_mul_f32 v[22:23], v[22:23], s[50:51]
v_cvt_pk_bf16_f32 v16, v16, v17
v_cvt_pk_bf16_f32 v18, v18, v19
v_cvt_pk_bf16_f32 v20, v20, v21
v_cvt_pk_bf16_f32 v22, v22, v23
v_accvgpr_write_b32 a20, v16
v_mov_b32 v84, 0
v_accvgpr_write_b32 a21, v18
v_mov_b32 v85, 0
v_accvgpr_write_b32 a22, v20
v_mov_b32 v86, 0
v_accvgpr_write_b32 a23, v22
v_mov_b32 v87, 0
s_waitcnt vmcnt(7)
buffer_load_dwordx4 v[120:123], v7, s[12:15], s35 offen offset:128 nt
v_lshlrev_b32 v16, 16, v88
v_and_b32 v17, s49, v88
v_lshlrev_b32 v18, 16, v89
v_and_b32 v19, s49, v89
v_lshlrev_b32 v20, 16, v90
v_and_b32 v21, s49, v90
v_lshlrev_b32 v22, 16, v91
v_and_b32 v23, s49, v91
v_pk_mul_f32 v[16:17], v[16:17], s[50:51]
v_pk_mul_f32 v[18:19], v[18:19], s[50:51]
v_pk_mul_f32 v[20:21], v[20:21], s[50:51]
v_pk_mul_f32 v[22:23], v[22:23], s[50:51]
v_cvt_pk_bf16_f32 v16, v16, v17
v_cvt_pk_bf16_f32 v18, v18, v19
v_cvt_pk_bf16_f32 v20, v20, v21
v_cvt_pk_bf16_f32 v22, v22, v23
v_accvgpr_write_b32 a24, v16
v_mov_b32 v88, 0
v_accvgpr_write_b32 a25, v18
v_mov_b32 v89, 0
v_accvgpr_write_b32 a26, v20
v_mov_b32 v90, 0
v_accvgpr_write_b32 a27, v22
v_mov_b32 v91, 0
s_waitcnt vmcnt(7)
buffer_load_dwordx4 v[124:127], v7, s[12:15], s35 offen offset:192 nt
v_lshlrev_b32 v16, 16, v92
v_and_b32 v17, s49, v92
v_lshlrev_b32 v18, 16, v93
v_and_b32 v19, s49, v93
v_lshlrev_b32 v20, 16, v94
v_and_b32 v21, s49, v94
v_lshlrev_b32 v22, 16, v95
v_and_b32 v23, s49, v95
v_pk_mul_f32 v[16:17], v[16:17], s[50:51]
v_pk_mul_f32 v[18:19], v[18:19], s[50:51]
v_pk_mul_f32 v[20:21], v[20:21], s[50:51]
v_pk_mul_f32 v[22:23], v[22:23], s[50:51]
v_cvt_pk_bf16_f32 v16, v16, v17
v_cvt_pk_bf16_f32 v18, v18, v19
v_cvt_pk_bf16_f32 v20, v20, v21
v_cvt_pk_bf16_f32 v22, v22, v23
v_accvgpr_write_b32 a28, v16
v_mov_b32 v92, 0
v_accvgpr_write_b32 a29, v18
v_mov_b32 v93, 0
v_accvgpr_write_b32 a30, v20
v_mov_b32 v94, 0
v_accvgpr_write_b32 a31, v22
v_mov_b32 v95, 0
s_nop 0
v_mfma_f32_16x16x32_bf16 v[36:39], a[96:99], a[16:19], 0
v_mfma_f32_16x16x32_bf16 v[36:39], a[100:103], a[20:23], v[36:39]
v_mfma_f32_16x16x32_bf16 v[36:39], a[104:107], a[24:27], v[36:39]
v_mfma_f32_16x16x32_bf16 v[36:39], a[108:111], a[28:31], v[36:39]
s_waitcnt vmcnt(7)
s_movk_i32 s35, 16384
buffer_load_dwordx4 v[128:131], v7, s[12:15], s35 offen offset:0 nt
v_lshlrev_b32 v16, 16, v96
v_and_b32 v17, s49, v96
v_lshlrev_b32 v18, 16, v97
v_and_b32 v19, s49, v97
v_lshlrev_b32 v20, 16, v98
v_and_b32 v21, s49, v98
v_lshlrev_b32 v22, 16, v99
v_and_b32 v23, s49, v99
v_pk_mul_f32 v[16:17], v[16:17], s[50:51]
v_pk_mul_f32 v[18:19], v[18:19], s[50:51]
v_pk_mul_f32 v[20:21], v[20:21], s[50:51]
v_pk_mul_f32 v[22:23], v[22:23], s[50:51]
v_cvt_pk_bf16_f32 v16, v16, v17
v_cvt_pk_bf16_f32 v18, v18, v19
v_cvt_pk_bf16_f32 v20, v20, v21
v_cvt_pk_bf16_f32 v22, v22, v23
v_accvgpr_write_b32 a32, v16
v_mov_b32 v96, 0
v_accvgpr_write_b32 a33, v18
v_mov_b32 v97, 0
v_accvgpr_write_b32 a34, v20
v_mov_b32 v98, 0
v_accvgpr_write_b32 a35, v22
v_mov_b32 v99, 0
v_max3_f32 v57, v36, v37, v38
v_max_f32 v57, v57, v39
s_waitcnt vmcnt(7)
buffer_load_dwordx4 v[132:135], v7, s[12:15], s35 offen offset:64 nt
v_lshlrev_b32 v16, 16, v100
v_and_b32 v17, s49, v100
v_lshlrev_b32 v18, 16, v101
v_and_b32 v19, s49, v101
v_lshlrev_b32 v20, 16, v102
v_and_b32 v21, s49, v102
v_lshlrev_b32 v22, 16, v103
v_and_b32 v23, s49, v103
v_pk_mul_f32 v[16:17], v[16:17], s[50:51]
v_pk_mul_f32 v[18:19], v[18:19], s[50:51]
v_pk_mul_f32 v[20:21], v[20:21], s[50:51]
v_pk_mul_f32 v[22:23], v[22:23], s[50:51]
v_cvt_pk_bf16_f32 v16, v16, v17
v_cvt_pk_bf16_f32 v18, v18, v19
v_cvt_pk_bf16_f32 v20, v20, v21
v_cvt_pk_bf16_f32 v22, v22, v23
v_accvgpr_write_b32 a36, v16
v_mov_b32 v100, 0
v_accvgpr_write_b32 a37, v18
v_mov_b32 v101, 0
v_accvgpr_write_b32 a38, v20
v_mov_b32 v102, 0
v_accvgpr_write_b32 a39, v22
v_mov_b32 v103, 0
s_waitcnt vmcnt(7)
buffer_load_dwordx4 v[136:139], v7, s[12:15], s35 offen offset:128 nt
v_lshlrev_b32 v16, 16, v104
v_and_b32 v17, s49, v104
v_lshlrev_b32 v18, 16, v105
v_and_b32 v19, s49, v105
v_lshlrev_b32 v20, 16, v106
v_and_b32 v21, s49, v106
v_lshlrev_b32 v22, 16, v107
v_and_b32 v23, s49, v107
v_pk_mul_f32 v[16:17], v[16:17], s[50:51]
v_pk_mul_f32 v[18:19], v[18:19], s[50:51]
v_pk_mul_f32 v[20:21], v[20:21], s[50:51]
v_pk_mul_f32 v[22:23], v[22:23], s[50:51]
v_cvt_pk_bf16_f32 v16, v16, v17
v_cvt_pk_bf16_f32 v18, v18, v19
v_cvt_pk_bf16_f32 v20, v20, v21
v_cvt_pk_bf16_f32 v22, v22, v23
v_accvgpr_write_b32 a40, v16
v_mov_b32 v104, 0
v_accvgpr_write_b32 a41, v18
v_mov_b32 v105, 0
v_accvgpr_write_b32 a42, v20
v_mov_b32 v106, 0
v_accvgpr_write_b32 a43, v22
v_mov_b32 v107, 0
s_waitcnt vmcnt(7)
buffer_load_dwordx4 v[140:143], v7, s[12:15], s35 offen offset:192 nt
v_lshlrev_b32 v16, 16, v108
v_and_b32 v17, s49, v108
v_lshlrev_b32 v18, 16, v109
v_and_b32 v19, s49, v109
v_lshlrev_b32 v20, 16, v110
v_and_b32 v21, s49, v110
v_lshlrev_b32 v22, 16, v111
v_and_b32 v23, s49, v111
v_pk_mul_f32 v[16:17], v[16:17], s[50:51]
v_pk_mul_f32 v[18:19], v[18:19], s[50:51]
v_pk_mul_f32 v[20:21], v[20:21], s[50:51]
v_pk_mul_f32 v[22:23], v[22:23], s[50:51]
v_cvt_pk_bf16_f32 v16, v16, v17
v_cvt_pk_bf16_f32 v18, v18, v19
v_cvt_pk_bf16_f32 v20, v20, v21
v_cvt_pk_bf16_f32 v22, v22, v23
v_accvgpr_write_b32 a44, v16
v_mov_b32 v108, 0
v_accvgpr_write_b32 a45, v18
v_mov_b32 v109, 0
v_accvgpr_write_b32 a46, v20
v_mov_b32 v110, 0
v_accvgpr_write_b32 a47, v22
v_mov_b32 v111, 0
s_nop 0
v_mfma_f32_16x16x32_bf16 v[40:43], a[96:99], a[32:35], 0
v_mfma_f32_16x16x32_bf16 v[40:43], a[100:103], a[36:39], v[40:43]
v_mfma_f32_16x16x32_bf16 v[40:43], a[104:107], a[40:43], v[40:43]
v_mfma_f32_16x16x32_bf16 v[40:43], a[108:111], a[44:47], v[40:43]
s_waitcnt vmcnt(7)
s_movk_i32 s35, 20480
buffer_load_dwordx4 v[144:147], v7, s[12:15], s35 offen offset:0 nt
v_lshlrev_b32 v16, 16, v112
v_and_b32 v17, s49, v112
v_lshlrev_b32 v18, 16, v113
v_and_b32 v19, s49, v113
v_lshlrev_b32 v20, 16, v114
v_and_b32 v21, s49, v114
v_lshlrev_b32 v22, 16, v115
v_and_b32 v23, s49, v115
v_pk_mul_f32 v[16:17], v[16:17], s[50:51]
v_pk_mul_f32 v[18:19], v[18:19], s[50:51]
v_pk_mul_f32 v[20:21], v[20:21], s[50:51]
v_pk_mul_f32 v[22:23], v[22:23], s[50:51]
v_cvt_pk_bf16_f32 v16, v16, v17
v_cvt_pk_bf16_f32 v18, v18, v19
v_cvt_pk_bf16_f32 v20, v20, v21
v_cvt_pk_bf16_f32 v22, v22, v23
v_accvgpr_write_b32 a48, v16
v_mov_b32 v112, 0
v_accvgpr_write_b32 a49, v18
v_mov_b32 v113, 0
v_accvgpr_write_b32 a50, v20
v_mov_b32 v114, 0
v_accvgpr_write_b32 a51, v22
v_mov_b32 v115, 0
v_max3_f32 v58, v40, v41, v42
v_max_f32 v58, v58, v43
s_waitcnt vmcnt(7)
buffer_load_dwordx4 v[148:151], v7, s[12:15], s35 offen offset:64 nt
v_lshlrev_b32 v16, 16, v116
v_and_b32 v17, s49, v116
v_lshlrev_b32 v18, 16, v117
v_and_b32 v19, s49, v117
v_lshlrev_b32 v20, 16, v118
v_and_b32 v21, s49, v118
v_lshlrev_b32 v22, 16, v119
v_and_b32 v23, s49, v119
v_pk_mul_f32 v[16:17], v[16:17], s[50:51]
v_pk_mul_f32 v[18:19], v[18:19], s[50:51]
v_pk_mul_f32 v[20:21], v[20:21], s[50:51]
v_pk_mul_f32 v[22:23], v[22:23], s[50:51]
v_cvt_pk_bf16_f32 v16, v16, v17
v_cvt_pk_bf16_f32 v18, v18, v19
v_cvt_pk_bf16_f32 v20, v20, v21
v_cvt_pk_bf16_f32 v22, v22, v23
v_accvgpr_write_b32 a52, v16
v_mov_b32 v116, 0
v_accvgpr_write_b32 a53, v18
v_mov_b32 v117, 0
v_accvgpr_write_b32 a54, v20
v_mov_b32 v118, 0
v_accvgpr_write_b32 a55, v22
v_mov_b32 v119, 0
s_waitcnt vmcnt(7)
buffer_load_dwordx4 v[152:155], v7, s[12:15], s35 offen offset:128 nt
v_lshlrev_b32 v16, 16, v120
v_and_b32 v17, s49, v120
v_lshlrev_b32 v18, 16, v121
v_and_b32 v19, s49, v121
v_lshlrev_b32 v20, 16, v122
v_and_b32 v21, s49, v122
v_lshlrev_b32 v22, 16, v123
v_and_b32 v23, s49, v123
v_pk_mul_f32 v[16:17], v[16:17], s[50:51]
v_pk_mul_f32 v[18:19], v[18:19], s[50:51]
v_pk_mul_f32 v[20:21], v[20:21], s[50:51]
v_pk_mul_f32 v[22:23], v[22:23], s[50:51]
v_cvt_pk_bf16_f32 v16, v16, v17
v_cvt_pk_bf16_f32 v18, v18, v19
v_cvt_pk_bf16_f32 v20, v20, v21
v_cvt_pk_bf16_f32 v22, v22, v23
v_accvgpr_write_b32 a56, v16
v_mov_b32 v120, 0
v_accvgpr_write_b32 a57, v18
v_mov_b32 v121, 0
v_accvgpr_write_b32 a58, v20
v_mov_b32 v122, 0
v_accvgpr_write_b32 a59, v22
v_mov_b32 v123, 0
s_waitcnt vmcnt(7)
buffer_load_dwordx4 v[156:159], v7, s[12:15], s35 offen offset:192 nt
v_lshlrev_b32 v16, 16, v124
v_and_b32 v17, s49, v124
v_lshlrev_b32 v18, 16, v125
v_and_b32 v19, s49, v125
v_lshlrev_b32 v20, 16, v126
v_and_b32 v21, s49, v126
v_lshlrev_b32 v22, 16, v127
v_and_b32 v23, s49, v127
v_pk_mul_f32 v[16:17], v[16:17], s[50:51]
v_pk_mul_f32 v[18:19], v[18:19], s[50:51]
v_pk_mul_f32 v[20:21], v[20:21], s[50:51]
v_pk_mul_f32 v[22:23], v[22:23], s[50:51]
v_cvt_pk_bf16_f32 v16, v16, v17
v_cvt_pk_bf16_f32 v18, v18, v19
v_cvt_pk_bf16_f32 v20, v20, v21
v_cvt_pk_bf16_f32 v22, v22, v23
v_accvgpr_write_b32 a60, v16
v_mov_b32 v124, 0
v_accvgpr_write_b32 a61, v18
v_mov_b32 v125, 0
v_accvgpr_write_b32 a62, v20
v_mov_b32 v126, 0
v_accvgpr_write_b32 a63, v22
v_mov_b32 v127, 0
s_nop 0
v_mfma_f32_16x16x32_bf16 v[44:47], a[96:99], a[48:51], 0
v_mfma_f32_16x16x32_bf16 v[44:47], a[100:103], a[52:55], v[44:47]
v_mfma_f32_16x16x32_bf16 v[44:47], a[104:107], a[56:59], v[44:47]
v_mfma_f32_16x16x32_bf16 v[44:47], a[108:111], a[60:63], v[44:47]
s_waitcnt vmcnt(7)
v_lshlrev_b32 v16, 16, v128
v_and_b32 v17, s49, v128
v_lshlrev_b32 v18, 16, v129
v_and_b32 v19, s49, v129
v_lshlrev_b32 v20, 16, v130
v_and_b32 v21, s49, v130
v_lshlrev_b32 v22, 16, v131
v_and_b32 v23, s49, v131
v_pk_mul_f32 v[16:17], v[16:17], s[50:51]
v_pk_mul_f32 v[18:19], v[18:19], s[50:51]
v_pk_mul_f32 v[20:21], v[20:21], s[50:51]
v_pk_mul_f32 v[22:23], v[22:23], s[50:51]
v_cvt_pk_bf16_f32 v16, v16, v17
v_cvt_pk_bf16_f32 v18, v18, v19
v_cvt_pk_bf16_f32 v20, v20, v21
v_cvt_pk_bf16_f32 v22, v22, v23
v_accvgpr_write_b32 a64, v16
v_mov_b32 v128, 0
v_accvgpr_write_b32 a65, v18
v_mov_b32 v129, 0
v_accvgpr_write_b32 a66, v20
v_mov_b32 v130, 0
v_accvgpr_write_b32 a67, v22
v_mov_b32 v131, 0
v_max3_f32 v59, v44, v45, v46
v_max_f32 v59, v59, v47
s_waitcnt vmcnt(6)
v_lshlrev_b32 v16, 16, v132
v_and_b32 v17, s49, v132
v_lshlrev_b32 v18, 16, v133
v_and_b32 v19, s49, v133
v_lshlrev_b32 v20, 16, v134
v_and_b32 v21, s49, v134
v_lshlrev_b32 v22, 16, v135
v_and_b32 v23, s49, v135
v_pk_mul_f32 v[16:17], v[16:17], s[50:51]
v_pk_mul_f32 v[18:19], v[18:19], s[50:51]
v_pk_mul_f32 v[20:21], v[20:21], s[50:51]
v_pk_mul_f32 v[22:23], v[22:23], s[50:51]
v_cvt_pk_bf16_f32 v16, v16, v17
v_cvt_pk_bf16_f32 v18, v18, v19
v_cvt_pk_bf16_f32 v20, v20, v21
v_cvt_pk_bf16_f32 v22, v22, v23
v_accvgpr_write_b32 a68, v16
v_mov_b32 v132, 0
v_accvgpr_write_b32 a69, v18
v_mov_b32 v133, 0
v_accvgpr_write_b32 a70, v20
v_mov_b32 v134, 0
v_accvgpr_write_b32 a71, v22
v_mov_b32 v135, 0
s_waitcnt vmcnt(5)
v_lshlrev_b32 v16, 16, v136
v_and_b32 v17, s49, v136
v_lshlrev_b32 v18, 16, v137
v_and_b32 v19, s49, v137
v_lshlrev_b32 v20, 16, v138
v_and_b32 v21, s49, v138
v_lshlrev_b32 v22, 16, v139
v_and_b32 v23, s49, v139
v_pk_mul_f32 v[16:17], v[16:17], s[50:51]
v_pk_mul_f32 v[18:19], v[18:19], s[50:51]
v_pk_mul_f32 v[20:21], v[20:21], s[50:51]
v_pk_mul_f32 v[22:23], v[22:23], s[50:51]
v_cvt_pk_bf16_f32 v16, v16, v17
v_cvt_pk_bf16_f32 v18, v18, v19
v_cvt_pk_bf16_f32 v20, v20, v21
v_cvt_pk_bf16_f32 v22, v22, v23
v_accvgpr_write_b32 a72, v16
v_mov_b32 v136, 0
v_accvgpr_write_b32 a73, v18
v_mov_b32 v137, 0
v_accvgpr_write_b32 a74, v20
v_mov_b32 v138, 0
v_accvgpr_write_b32 a75, v22
v_mov_b32 v139, 0
s_waitcnt vmcnt(4)
v_lshlrev_b32 v16, 16, v140
v_and_b32 v17, s49, v140
v_lshlrev_b32 v18, 16, v141
v_and_b32 v19, s49, v141
v_lshlrev_b32 v20, 16, v142
v_and_b32 v21, s49, v142
v_lshlrev_b32 v22, 16, v143
v_and_b32 v23, s49, v143
v_pk_mul_f32 v[16:17], v[16:17], s[50:51]
v_pk_mul_f32 v[18:19], v[18:19], s[50:51]
v_pk_mul_f32 v[20:21], v[20:21], s[50:51]
v_pk_mul_f32 v[22:23], v[22:23], s[50:51]
v_cvt_pk_bf16_f32 v16, v16, v17
v_cvt_pk_bf16_f32 v18, v18, v19
v_cvt_pk_bf16_f32 v20, v20, v21
v_cvt_pk_bf16_f32 v22, v22, v23
v_accvgpr_write_b32 a76, v16
v_mov_b32 v140, 0
v_accvgpr_write_b32 a77, v18
v_mov_b32 v141, 0
v_accvgpr_write_b32 a78, v20
v_mov_b32 v142, 0
v_accvgpr_write_b32 a79, v22
v_mov_b32 v143, 0
s_nop 0
v_mfma_f32_16x16x32_bf16 v[48:51], a[96:99], a[64:67], 0
v_mfma_f32_16x16x32_bf16 v[48:51], a[100:103], a[68:71], v[48:51]
v_mfma_f32_16x16x32_bf16 v[48:51], a[104:107], a[72:75], v[48:51]
v_mfma_f32_16x16x32_bf16 v[48:51], a[108:111], a[76:79], v[48:51]
s_waitcnt vmcnt(3)
v_lshlrev_b32 v16, 16, v144
v_and_b32 v17, s49, v144
v_lshlrev_b32 v18, 16, v145
v_and_b32 v19, s49, v145
v_lshlrev_b32 v20, 16, v146
v_and_b32 v21, s49, v146
v_lshlrev_b32 v22, 16, v147
v_and_b32 v23, s49, v147
v_pk_mul_f32 v[16:17], v[16:17], s[50:51]
v_pk_mul_f32 v[18:19], v[18:19], s[50:51]
v_pk_mul_f32 v[20:21], v[20:21], s[50:51]
v_pk_mul_f32 v[22:23], v[22:23], s[50:51]
v_cvt_pk_bf16_f32 v16, v16, v17
v_cvt_pk_bf16_f32 v18, v18, v19
v_cvt_pk_bf16_f32 v20, v20, v21
v_cvt_pk_bf16_f32 v22, v22, v23
v_accvgpr_write_b32 a80, v16
v_mov_b32 v144, 0
v_accvgpr_write_b32 a81, v18
v_mov_b32 v145, 0
v_accvgpr_write_b32 a82, v20
v_mov_b32 v146, 0
v_accvgpr_write_b32 a83, v22
v_mov_b32 v147, 0
v_max3_f32 v60, v48, v49, v50
v_max_f32 v60, v60, v51
v_mov_b32 v24, v56
v_mov_b32 v25, v57
v_mov_b32 v26, v58
v_mov_b32 v27, v59
v_mov_b32 v28, v60
v_permlane16_swap_b32 v24, v56
v_permlane16_swap_b32 v25, v57
v_permlane16_swap_b32 v26, v58
v_permlane16_swap_b32 v27, v59
v_permlane16_swap_b32 v28, v60
v_max_f32 v56, v56, v24
v_max_f32 v57, v57, v25
v_max_f32 v58, v58, v26
v_max_f32 v59, v59, v27
v_max_f32 v60, v60, v28
v_mov_b32 v24, v56
v_mov_b32 v25, v57
v_mov_b32 v26, v58
v_mov_b32 v27, v59
v_mov_b32 v28, v60
v_permlane32_swap_b32 v24, v56
v_permlane32_swap_b32 v25, v57
v_permlane32_swap_b32 v26, v58
v_permlane32_swap_b32 v27, v59
v_permlane32_swap_b32 v28, v60
v_max_f32 v56, v56, v24
v_max_f32 v57, v57, v25
v_max_f32 v58, v58, v26
v_max_f32 v59, v59, v27
v_max_f32 v60, v60, v28
v_sub_f32 v8, v8, v56
v_sub_f32 v9, v9, v56
v_sub_f32 v10, v10, v56
v_sub_f32 v11, v11, v56
v_sub_f32 v12, v12, v56
v_sub_f32 v13, v13, v56
v_sub_f32 v14, v14, v56
v_sub_f32 v15, v15, v56
v_mov_b32 v24, 0
v_mov_b32 v25, 0
v_mov_b32 v26, 0
v_mov_b32 v27, 0
v_sub_f32 v32, 0, v56
v_sub_f32 v33, 0, v56
v_sub_f32 v34, 0, v56
v_sub_f32 v35, 0, v56
v_sub_f32 v36, 0, v57
v_sub_f32 v37, 0, v57
v_sub_f32 v38, 0, v57
v_sub_f32 v39, 0, v57
v_sub_f32 v40, 0, v58
v_sub_f32 v41, 0, v58
v_sub_f32 v42, 0, v58
v_sub_f32 v43, 0, v58
v_sub_f32 v44, 0, v59
v_sub_f32 v45, 0, v59
v_sub_f32 v46, 0, v59
v_sub_f32 v47, 0, v59
v_sub_f32 v48, 0, v60
v_sub_f32 v49, 0, v60
v_sub_f32 v50, 0, v60
v_sub_f32 v51, 0, v60
s_waitcnt vmcnt(2)
v_lshlrev_b32 v16, 16, v148
v_and_b32 v17, s49, v148
v_lshlrev_b32 v18, 16, v149
v_and_b32 v19, s49, v149
v_lshlrev_b32 v20, 16, v150
v_and_b32 v21, s49, v150
v_lshlrev_b32 v22, 16, v151
v_and_b32 v23, s49, v151
v_pk_mul_f32 v[16:17], v[16:17], s[50:51]
v_pk_mul_f32 v[18:19], v[18:19], s[50:51]
v_pk_mul_f32 v[20:21], v[20:21], s[50:51]
v_pk_mul_f32 v[22:23], v[22:23], s[50:51]
v_cvt_pk_bf16_f32 v16, v16, v17
v_cvt_pk_bf16_f32 v18, v18, v19
v_cvt_pk_bf16_f32 v20, v20, v21
v_cvt_pk_bf16_f32 v22, v22, v23
v_accvgpr_write_b32 a84, v16
v_mov_b32 v148, 0
v_accvgpr_write_b32 a85, v18
v_mov_b32 v149, 0
v_accvgpr_write_b32 a86, v20
v_mov_b32 v150, 0
v_accvgpr_write_b32 a87, v22
v_mov_b32 v151, 0
s_waitcnt vmcnt(1)
v_lshlrev_b32 v16, 16, v152
v_and_b32 v17, s49, v152
v_lshlrev_b32 v18, 16, v153
v_and_b32 v19, s49, v153
v_lshlrev_b32 v20, 16, v154
v_and_b32 v21, s49, v154
v_lshlrev_b32 v22, 16, v155
v_and_b32 v23, s49, v155
v_pk_mul_f32 v[16:17], v[16:17], s[50:51]
v_pk_mul_f32 v[18:19], v[18:19], s[50:51]
v_pk_mul_f32 v[20:21], v[20:21], s[50:51]
v_pk_mul_f32 v[22:23], v[22:23], s[50:51]
v_cvt_pk_bf16_f32 v16, v16, v17
v_cvt_pk_bf16_f32 v18, v18, v19
v_cvt_pk_bf16_f32 v20, v20, v21
v_cvt_pk_bf16_f32 v22, v22, v23
v_accvgpr_write_b32 a88, v16
v_mov_b32 v152, 0
v_accvgpr_write_b32 a89, v18
v_mov_b32 v153, 0
v_accvgpr_write_b32 a90, v20
v_mov_b32 v154, 0
v_accvgpr_write_b32 a91, v22
v_mov_b32 v155, 0
s_waitcnt vmcnt(0)
v_lshlrev_b32 v16, 16, v156
v_and_b32 v17, s49, v156
v_lshlrev_b32 v18, 16, v157
v_and_b32 v19, s49, v157
v_lshlrev_b32 v20, 16, v158
v_and_b32 v21, s49, v158
v_lshlrev_b32 v22, 16, v159
v_and_b32 v23, s49, v159
v_pk_mul_f32 v[16:17], v[16:17], s[50:51]
v_pk_mul_f32 v[18:19], v[18:19], s[50:51]
v_pk_mul_f32 v[20:21], v[20:21], s[50:51]
v_pk_mul_f32 v[22:23], v[22:23], s[50:51]
v_cvt_pk_bf16_f32 v16, v16, v17
v_cvt_pk_bf16_f32 v18, v18, v19
v_cvt_pk_bf16_f32 v20, v20, v21
v_cvt_pk_bf16_f32 v22, v22, v23
v_accvgpr_write_b32 a92, v16
v_mov_b32 v156, 0
v_accvgpr_write_b32 a93, v18
v_mov_b32 v157, 0
v_accvgpr_write_b32 a94, v20
v_mov_b32 v158, 0
v_accvgpr_write_b32 a95, v22
v_mov_b32 v159, 0
s_nop 0
v_mfma_f32_16x16x32_bf16 v[52:55], a[96:99], a[80:83], 0
v_mfma_f32_16x16x32_bf16 v[52:55], a[100:103], a[84:87], v[52:55]
v_mfma_f32_16x16x32_bf16 v[52:55], a[104:107], a[88:91], v[52:55]
v_mfma_f32_16x16x32_bf16 v[52:55], a[108:111], a[92:95], v[52:55]
s_nop 7
v_max3_f32 v61, v52, v53, v54
v_max_f32 v61, v61, v55
v_mov_b32 v16, v61
s_nop 1
v_permlane16_swap_b32 v16, v61
s_nop 1
v_max_f32 v61, v61, v16
v_mov_b32 v16, v61
s_nop 1
v_permlane32_swap_b32 v16, v61
s_nop 1
v_max_f32 v61, v61, v16
v_sub_f32 v52, 0, v61
v_sub_f32 v53, 0, v61
v_sub_f32 v54, 0, v61
v_sub_f32 v55, 0, v61
.p2align 6
L_loop:
v_mfma_f32_16x16x32_bf16 v[16:19], a[96:99], a[16:19], v[36:39]
v_exp_f32 v8, v8
v_mfma_f32_16x16x32_bf16 v[16:19], a[100:103], a[20:23], v[16:19]
v_exp_f32 v9, v9
v_mfma_f32_16x16x32_bf16 v[16:19], a[104:107], a[24:27], v[16:19]
v_exp_f32 v10, v10
v_mfma_f32_16x16x32_bf16 v[16:19], a[108:111], a[28:31], v[16:19]
v_exp_f32 v11, v11
v_mfma_f32_16x16x32_bf16 v[20:23], a[112:115], a[16:19], v[36:39]
v_exp_f32 v12, v12
v_mfma_f32_16x16x32_bf16 v[20:23], a[116:119], a[20:23], v[20:23]
v_exp_f32 v13, v13
v_mfma_f32_16x16x32_bf16 v[20:23], a[120:123], a[24:27], v[20:23]
v_exp_f32 v14, v14
v_mfma_f32_16x16x32_bf16 v[20:23], a[124:127], a[28:31], v[20:23]
s_bitcmp1_b32 s55, s44
v_exp_f32 v15, v15
s_cbranch_scc0 L_siteL_off
v_mfma_f32_16x16x32_bf16 a[184:187], a[160:163], v[24:27], a[184:187]
s_add_u32 m0, s43, 8448
v_cvt_pk_bf16_f32 v8, v8, v9
v_cvt_pk_bf16_f32 v9, v10, v11
v_mfma_f32_16x16x32_bf16 v[224:227], a[128:131], v[24:27], v[224:227]
buffer_load_dwordx4 v3, s[16:19], 0 offen offset:0 nt lds
s_add_u32 m0, m0, 32
ds_read_b64_tr_b16 a[128:129], v2 offset:0
ds_read_b64_tr_b16 a[130:131], v2 offset:512
v_cvt_pk_bf16_f32 v10, v12, v13
v_mfma_f32_16x16x32_bf16 v[228:231], a[132:135], v[24:27], v[228:231]
buffer_load_dwordx4 v3, s[16:19], 0 offen offset:1024 nt lds
s_add_u32 m0, m0, 32
ds_read_b64_tr_b16 a[132:133], v2 offset:32
ds_read_b64_tr_b16 a[134:135], v2 offset:544
v_cvt_pk_bf16_f32 v11, v14, v15
v_mfma_f32_16x16x32_bf16 v[232:235], a[136:139], v[24:27], v[232:235]
buffer_load_dwordx4 v3, s[16:19], 0 offen offset:2048 nt lds
s_add_u32 m0, m0, 32
ds_read_b64_tr_b16 a[136:137], v2 offset:64
ds_read_b64_tr_b16 a[138:139], v2 offset:576
v_mfma_f32_16x16x32_bf16 v[236:239], a[140:143], v[24:27], v[236:239]
buffer_load_dwordx4 v3, s[16:19], 0 offen offset:3072 nt lds
s_mov_b32 m0, s43
ds_read_b64_tr_b16 a[140:141], v2 offset:96
ds_read_b64_tr_b16 a[142:143], v2 offset:608
v_mfma_f32_16x16x32_bf16 v[240:243], a[144:147], v[24:27], v[240:243]
buffer_load_dwordx4 v3, s[20:23], 0 offen offset:0 nt lds
s_add_u32 m0, m0, 32
ds_read_b64_tr_b16 a[144:145], v2 offset:128
ds_read_b64_tr_b16 a[146:147], v2 offset:640
v_mfma_f32_16x16x32_bf16 v[244:247], a[148:151], v[24:27], v[244:247]
buffer_load_dwordx4 v3, s[20:23], 0 offen offset:1024 nt lds
s_add_u32 m0, m0, 32
ds_read_b64_tr_b16 a[148:149], v2 offset:160
ds_read_b64_tr_b16 a[150:151], v2 offset:672
v_mfma_f32_16x16x32_bf16 v[248:251], a[152:155], v[24:27], v[248:251]
buffer_load_dwordx4 v3, s[20:23], 0 offen offset:2048 nt lds
s_add_u32 m0, m0, 32
ds_read_b64_tr_b16 a[152:153], v2 offset:192
ds_read_b64_tr_b16 a[154:155], v2 offset:704
v_mfma_f32_16x16x32_bf16 v[252:255], a[156:159], v[24:27], v[252:255]
buffer_load_dwordx4 v3, s[20:23], 0 offen offset:3072 nt lds
ds_read_b64_tr_b16 a[156:157], v2 offset:224
ds_read_b64_tr_b16 a[158:159], v2 offset:736
v_add_u32 v3, 0x2000, v3
s_add_u32 s43, s43, 16896
s_cmp_ge_u32 s43, s42
s_cselect_b32 s43, s40, s43
L_siteL_join:
v_mfma_f32_16x16x32_bf16 v[24:27], a[96:99], a[32:35], v[40:43]
v_exp_f32 v16, v16
v_mfma_f32_16x16x32_bf16 v[24:27], a[100:103], a[36:39], v[24:27]
v_exp_f32 v17, v17
v_mfma_f32_16x16x32_bf16 v[24:27], a[104:107], a[40:43], v[24:27]
v_exp_f32 v18, v18
v_mfma_f32_16x16x32_bf16 v[24:27], a[108:111], a[44:47], v[24:27]
v_exp_f32 v19, v19
v_mfma_f32_16x16x32_bf16 v[28:31], a[112:115], a[32:35], v[40:43]
v_exp_f32 v20, v20
v_mfma_f32_16x16x32_bf16 v[28:31], a[116:119], a[36:39], v[28:31]
v_exp_f32 v21, v21
v_mfma_f32_16x16x32_bf16 v[28:31], a[120:123], a[40:43], v[28:31]
v_exp_f32 v22, v22
v_mfma_f32_16x16x32_bf16 v[28:31], a[124:127], a[44:47], v[28:31]
v_exp_f32 v23, v23
s_waitcnt lgkmcnt(0)
v_mfma_f32_16x16x32_bf16 a[164:167], a[160:163], v[8:11], a[164:167]
v_cvt_pk_bf16_f32 v16, v16, v17
v_cvt_pk_bf16_f32 v17, v18, v19
v_mfma_f32_16x16x32_bf16 v[64:67], a[128:131], v[8:11], v[64:67]
v_cvt_pk_bf16_f32 v18, v20, v21
v_mfma_f32_16x16x32_bf16 v[68:71], a[132:135], v[8:11], v[68:71]
v_cvt_pk_bf16_f32 v19, v22, v23
v_mfma_f32_16x16x32_bf16 v[72:75], a[136:139], v[8:11], v[72:75]
v_mfma_f32_16x16x32_bf16 v[76:79], a[140:143], v[8:11], v[76:79]
v_mfma_f32_16x16x32_bf16 v[80:83], a[144:147], v[8:11], v[80:83]
v_mfma_f32_16x16x32_bf16 v[84:87], a[148:151], v[8:11], v[84:87]
v_mfma_f32_16x16x32_bf16 v[88:91], a[152:155], v[8:11], v[88:91]
v_mfma_f32_16x16x32_bf16 v[92:95], a[156:159], v[8:11], v[92:95]
v_mfma_f32_16x16x32_bf16 v[8:11], a[96:99], a[48:51], v[44:47]
v_exp_f32 v24, v24
v_mfma_f32_16x16x32_bf16 v[8:11], a[100:103], a[52:55], v[8:11]
v_exp_f32 v25, v25
v_mfma_f32_16x16x32_bf16 v[8:11], a[104:107], a[56:59], v[8:11]
v_exp_f32 v26, v26
v_mfma_f32_16x16x32_bf16 v[8:11], a[108:111], a[60:63], v[8:11]
v_exp_f32 v27, v27
v_mfma_f32_16x16x32_bf16 v[12:15], a[112:115], a[48:51], v[44:47]
v_exp_f32 v28, v28
v_mfma_f32_16x16x32_bf16 v[12:15], a[116:119], a[52:55], v[12:15]
v_exp_f32 v29, v29
v_mfma_f32_16x16x32_bf16 v[12:15], a[120:123], a[56:59], v[12:15]
v_exp_f32 v30, v30
v_mfma_f32_16x16x32_bf16 v[12:15], a[124:127], a[60:63], v[12:15]
v_exp_f32 v31, v31
v_mfma_f32_16x16x32_bf16 a[168:171], a[160:163], v[16:19], a[168:171]
v_cvt_pk_bf16_f32 v24, v24, v25
v_cvt_pk_bf16_f32 v25, v26, v27
v_mfma_f32_16x16x32_bf16 v[96:99], a[128:131], v[16:19], v[96:99]
v_cvt_pk_bf16_f32 v26, v28, v29
v_mfma_f32_16x16x32_bf16 v[100:103], a[132:135], v[16:19], v[100:103]
v_cvt_pk_bf16_f32 v27, v30, v31
v_mfma_f32_16x16x32_bf16 v[104:107], a[136:139], v[16:19], v[104:107]
v_mfma_f32_16x16x32_bf16 v[108:111], a[140:143], v[16:19], v[108:111]
v_mfma_f32_16x16x32_bf16 v[112:115], a[144:147], v[16:19], v[112:115]
v_mfma_f32_16x16x32_bf16 v[116:119], a[148:151], v[16:19], v[116:119]
v_mfma_f32_16x16x32_bf16 v[120:123], a[152:155], v[16:19], v[120:123]
v_mfma_f32_16x16x32_bf16 v[124:127], a[156:159], v[16:19], v[124:127]
v_mfma_f32_16x16x32_bf16 v[16:19], a[96:99], a[64:67], v[48:51]
v_exp_f32 v8, v8
v_mfma_f32_16x16x32_bf16 v[16:19], a[100:103], a[68:71], v[16:19]
v_exp_f32 v9, v9
v_mfma_f32_16x16x32_bf16 v[16:19], a[104:107], a[72:75], v[16:19]
v_exp_f32 v10, v10
v_mfma_f32_16x16x32_bf16 v[16:19], a[108:111], a[76:79], v[16:19]
v_exp_f32 v11, v11
v_mfma_f32_16x16x32_bf16 v[20:23], a[112:115], a[64:67], v[48:51]
v_exp_f32 v12, v12
v_mfma_f32_16x16x32_bf16 v[20:23], a[116:119], a[68:71], v[20:23]
v_exp_f32 v13, v13
v_mfma_f32_16x16x32_bf16 v[20:23], a[120:123], a[72:75], v[20:23]
v_exp_f32 v14, v14
v_mfma_f32_16x16x32_bf16 v[20:23], a[124:127], a[76:79], v[20:23]
v_exp_f32 v15, v15
v_mfma_f32_16x16x32_bf16 a[172:175], a[160:163], v[24:27], a[172:175]
v_cvt_pk_bf16_f32 v8, v8, v9
v_cvt_pk_bf16_f32 v9, v10, v11
v_mfma_f32_16x16x32_bf16 v[128:131], a[128:131], v[24:27], v[128:131]
v_cvt_pk_bf16_f32 v10, v12, v13
v_mfma_f32_16x16x32_bf16 v[132:135], a[132:135], v[24:27], v[132:135]
v_cvt_pk_bf16_f32 v11, v14, v15
v_mfma_f32_16x16x32_bf16 v[136:139], a[136:139], v[24:27], v[136:139]
s_add_u32 s45, s45, 16896
v_mfma_f32_16x16x32_bf16 v[140:143], a[140:143], v[24:27], v[140:143]
s_cmp_ge_u32 s45, 50688
s_cselect_b32 s46, 50688, 0
v_mfma_f32_16x16x32_bf16 v[144:147], a[144:147], v[24:27], v[144:147]
s_sub_u32 s45, s45, s46
v_mfma_f32_16x16x32_bf16 v[148:151], a[148:151], v[24:27], v[148:151]
s_sub_u32 s46, 16896, s46
v_mfma_f32_16x16x32_bf16 v[152:155], a[152:155], v[24:27], v[152:155]
v_add_u32 v1, s46, v1
v_add_u32 v2, s46, v2
v_mfma_f32_16x16x32_bf16 v[156:159], a[156:159], v[24:27], v[156:159]
s_bitcmp1_b32 s56, s44
s_cbranch_scc1 L_wait8
s_waitcnt vmcnt(0)
L_wait8:
s_waitcnt vmcnt(8)
s_barrier
v_mfma_f32_16x16x32_bf16 v[24:27], a[96:99], a[80:83], v[52:55]
ds_read_b128 a[96:99], v1 offset:8448
v_exp_f32 v16, v16
v_mfma_f32_16x16x32_bf16 v[24:27], a[100:103], a[84:87], v[24:27]
ds_read_b128 a[100:103], v1 offset:8512
v_exp_f32 v17, v17
v_mfma_f32_16x16x32_bf16 v[24:27], a[104:107], a[88:91], v[24:27]
ds_read_b128 a[104:107], v1 offset:8576
v_exp_f32 v18, v18
v_mfma_f32_16x16x32_bf16 v[24:27], a[108:111], a[92:95], v[24:27]
ds_read_b128 a[108:111], v1 offset:8640
v_exp_f32 v19, v19
v_mfma_f32_16x16x32_bf16 v[28:31], a[112:115], a[80:83], v[52:55]
ds_read_b128 a[112:115], v1 offset:8960
v_exp_f32 v20, v20
v_mfma_f32_16x16x32_bf16 v[28:31], a[116:119], a[84:87], v[28:31]
ds_read_b128 a[116:119], v1 offset:9024
v_exp_f32 v21, v21
v_mfma_f32_16x16x32_bf16 v[28:31], a[120:123], a[88:91], v[28:31]
ds_read_b128 a[120:123], v1 offset:9088
v_exp_f32 v22, v22
v_mfma_f32_16x16x32_bf16 v[28:31], a[124:127], a[92:95], v[28:31]
s_bitcmp1_b32 s54, s44
ds_read_b128 a[124:127], v1 offset:9152
v_exp_f32 v23, v23
s_cbranch_scc1 L_siteE_on
v_mfma_f32_16x16x32_bf16 a[176:179], a[160:163], v[8:11], a[176:179]
v_cvt_pk_bf16_f32 v16, v16, v17
v_cvt_pk_bf16_f32 v17, v18, v19
v_mfma_f32_16x16x32_bf16 v[160:163], a[128:131], v[8:11], v[160:163]
v_cvt_pk_bf16_f32 v18, v20, v21
v_mfma_f32_16x16x32_bf16 v[164:167], a[132:135], v[8:11], v[164:167]
v_cvt_pk_bf16_f32 v19, v22, v23
v_mfma_f32_16x16x32_bf16 v[168:171], a[136:139], v[8:11], v[168:171]
v_mfma_f32_16x16x32_bf16 v[172:175], a[140:143], v[8:11], v[172:175]
v_mfma_f32_16x16x32_bf16 v[176:179], a[144:147], v[8:11], v[176:179]
v_mfma_f32_16x16x32_bf16 v[180:183], a[148:151], v[8:11], v[180:183]
v_mfma_f32_16x16x32_bf16 v[184:187], a[152:155], v[8:11], v[184:187]
v_mfma_f32_16x16x32_bf16 v[188:191], a[156:159], v[8:11], v[188:191]
L_siteE_join:
s_waitcnt lgkmcnt(0)
v_mfma_f32_16x16x32_bf16 v[8:11], a[96:99], a[0:3], v[32:35]
v_exp_f32 v24, v24
v_mfma_f32_16x16x32_bf16 v[8:11], a[100:103], a[4:7], v[8:11]
v_exp_f32 v25, v25
v_mfma_f32_16x16x32_bf16 v[8:11], a[104:107], a[8:11], v[8:11]
v_exp_f32 v26, v26
v_mfma_f32_16x16x32_bf16 v[8:11], a[108:111], a[12:15], v[8:11]
v_exp_f32 v27, v27
v_mfma_f32_16x16x32_bf16 v[12:15], a[112:115], a[0:3], v[32:35]
v_exp_f32 v28, v28
v_mfma_f32_16x16x32_bf16 v[12:15], a[116:119], a[4:7], v[12:15]
v_exp_f32 v29, v29
v_mfma_f32_16x16x32_bf16 v[12:15], a[120:123], a[8:11], v[12:15]
v_exp_f32 v30, v30
v_mfma_f32_16x16x32_bf16 v[12:15], a[124:127], a[12:15], v[12:15]
v_exp_f32 v31, v31
v_mfma_f32_16x16x32_bf16 a[180:183], a[160:163], v[16:19], a[180:183]
v_cvt_pk_bf16_f32 v24, v24, v25
v_cvt_pk_bf16_f32 v25, v26, v27
v_mfma_f32_16x16x32_bf16 v[192:195], a[128:131], v[16:19], v[192:195]
v_cvt_pk_bf16_f32 v26, v28, v29
v_mfma_f32_16x16x32_bf16 v[196:199], a[132:135], v[16:19], v[196:199]
v_cvt_pk_bf16_f32 v27, v30, v31
v_mfma_f32_16x16x32_bf16 v[200:203], a[136:139], v[16:19], v[200:203]
v_mfma_f32_16x16x32_bf16 v[204:207], a[140:143], v[16:19], v[204:207]
v_mfma_f32_16x16x32_bf16 v[208:211], a[144:147], v[16:19], v[208:211]
v_mfma_f32_16x16x32_bf16 v[212:215], a[148:151], v[16:19], v[212:215]
s_add_u32 s44, s44, 1
v_mfma_f32_16x16x32_bf16 v[216:219], a[152:155], v[16:19], v[216:219]
v_mfma_f32_16x16x32_bf16 v[220:223], a[156:159], v[16:19], v[220:223]
s_cmp_lt_u32 s44, 31
s_cbranch_scc1 L_loop
L_last:
v_mfma_f32_16x16x32_bf16 v[16:19], a[96:99], a[16:19], v[36:39]
v_exp_f32 v8, v8
v_mfma_f32_16x16x32_bf16 v[16:19], a[100:103], a[20:23], v[16:19]
v_exp_f32 v9, v9
v_mfma_f32_16x16x32_bf16 v[16:19], a[104:107], a[24:27], v[16:19]
v_exp_f32 v10, v10
v_mfma_f32_16x16x32_bf16 v[16:19], a[108:111], a[28:31], v[16:19]
v_exp_f32 v11, v11
v_mfma_f32_16x16x32_bf16 v[20:23], a[112:115], a[16:19], v[36:39]
v_exp_f32 v12, v12
v_mfma_f32_16x16x32_bf16 v[20:23], a[116:119], a[20:23], v[20:23]
v_exp_f32 v13, v13
v_mfma_f32_16x16x32_bf16 v[20:23], a[120:123], a[24:27], v[20:23]
v_exp_f32 v14, v14
v_mfma_f32_16x16x32_bf16 v[20:23], a[124:127], a[28:31], v[20:23]
v_exp_f32 v15, v15
v_mfma_f32_16x16x32_bf16 a[184:187], a[160:163], v[24:27], a[184:187]
v_cvt_pk_bf16_f32 v8, v8, v9
v_cvt_pk_bf16_f32 v9, v10, v11
v_mfma_f32_16x16x32_bf16 v[224:227], a[128:131], v[24:27], v[224:227]
ds_read_b64_tr_b16 a[128:129], v2 offset:0
ds_read_b64_tr_b16 a[130:131], v2 offset:512
v_cvt_pk_bf16_f32 v10, v12, v13
v_mfma_f32_16x16x32_bf16 v[228:231], a[132:135], v[24:27], v[228:231]
ds_read_b64_tr_b16 a[132:133], v2 offset:32
ds_read_b64_tr_b16 a[134:135], v2 offset:544
v_cvt_pk_bf16_f32 v11, v14, v15
v_mfma_f32_16x16x32_bf16 v[232:235], a[136:139], v[24:27], v[232:235]
ds_read_b64_tr_b16 a[136:137], v2 offset:64
ds_read_b64_tr_b16 a[138:139], v2 offset:576
v_mfma_f32_16x16x32_bf16 v[236:239], a[140:143], v[24:27], v[236:239]
ds_read_b64_tr_b16 a[140:141], v2 offset:96
ds_read_b64_tr_b16 a[142:143], v2 offset:608
v_mfma_f32_16x16x32_bf16 v[240:243], a[144:147], v[24:27], v[240:243]
ds_read_b64_tr_b16 a[144:145], v2 offset:128
ds_read_b64_tr_b16 a[146:147], v2 offset:640
v_mfma_f32_16x16x32_bf16 v[244:247], a[148:151], v[24:27], v[244:247]
ds_read_b64_tr_b16 a[148:149], v2 offset:160
ds_read_b64_tr_b16 a[150:151], v2 offset:672
v_mfma_f32_16x16x32_bf16 v[248:251], a[152:155], v[24:27], v[248:251]
ds_read_b64_tr_b16 a[152:153], v2 offset:192
ds_read_b64_tr_b16 a[154:155], v2 offset:704
v_mfma_f32_16x16x32_bf16 v[252:255], a[156:159], v[24:27], v[252:255]
ds_read_b64_tr_b16 a[156:157], v2 offset:224
ds_read_b64_tr_b16 a[158:159], v2 offset:736
v_mfma_f32_16x16x32_bf16 v[24:27], a[96:99], a[32:35], v[40:43]
v_exp_f32 v16, v16
s_mul_i32 s47, s3, 33792
s_mov_b32 s48, 0x53800000
s_mov_b64 s[52:53], 0
v_mfma_f32_16x16x32_bf16 v[24:27], a[100:103], a[36:39], v[24:27]
v_exp_f32 v17, v17
v_and_b32 v56, 15, v0
v_lshrrev_b32 v57, 4, v0
v_mul_u32_u24 v4, 272, v56
v_mfma_f32_16x16x32_bf16 v[24:27], a[104:107], a[40:43], v[24:27]
v_exp_f32 v18, v18
v_lshl_add_u32 v4, v57, 3, v4
v_add_u32 v4, s47, v4
v_mul_u32_u24 v5, 272, v57
v_mfma_f32_16x16x32_bf16 v[24:27], a[108:111], a[44:47], v[24:27]
v_exp_f32 v19, v19
v_lshl_add_u32 v5, v56, 4, v5
v_add_u32 v5, s47, v5
v_lshlrev_b32 v3, 4, v0
v_mfma_f32_16x16x32_bf16 v[28:31], a[112:115], a[32:35], v[40:43]
v_exp_f32 v20, v20
v_lshlrev_b32 v58, 2, v56
s_movk_i32 s84, 4096
s_movk_i32 s85, 8192
v_mfma_f32_16x16x32_bf16 v[28:31], a[116:119], a[36:39], v[28:31]
v_exp_f32 v21, v21
s_movk_i32 s86, 12288
s_movk_i32 s87, 16384
s_movk_i32 s88, 20480
v_mfma_f32_16x16x32_bf16 v[28:31], a[120:123], a[40:43], v[28:31]
v_exp_f32 v22, v22
v_mfma_f32_16x16x32_bf16 v[28:31], a[124:127], a[44:47], v[28:31]
v_exp_f32 v23, v23
s_waitcnt lgkmcnt(0)
v_mfma_f32_16x16x32_bf16 a[164:167], a[160:163], v[8:11], a[164:167]
v_cvt_pk_bf16_f32 v16, v16, v17
v_cvt_pk_bf16_f32 v17, v18, v19
v_mfma_f32_16x16x32_bf16 v[64:67], a[128:131], v[8:11], v[64:67]
v_cvt_pk_bf16_f32 v18, v20, v21
v_mfma_f32_16x16x32_bf16 v[68:71], a[132:135], v[8:11], v[68:71]
v_cvt_pk_bf16_f32 v19, v22, v23
v_mfma_f32_16x16x32_bf16 v[72:75], a[136:139], v[8:11], v[72:75]
v_mfma_f32_16x16x32_bf16 v[76:79], a[140:143], v[8:11], v[76:79]
v_mfma_f32_16x16x32_bf16 v[80:83], a[144:147], v[8:11], v[80:83]
v_mfma_f32_16x16x32_bf16 v[84:87], a[148:151], v[8:11], v[84:87]
v_mfma_f32_16x16x32_bf16 v[88:91], a[152:155], v[8:11], v[88:91]
v_mfma_f32_16x16x32_bf16 v[92:95], a[156:159], v[8:11], v[92:95]
ds_bpermute_b32 a165, v58, a164
v_mfma_f32_16x16x32_bf16 v[8:11], a[96:99], a[48:51], v[44:47]
v_exp_f32 v24, v24
v_mfma_f32_16x16x32_bf16 v[8:11], a[100:103], a[52:55], v[8:11]
v_exp_f32 v25, v25
v_mfma_f32_16x16x32_bf16 v[8:11], a[104:107], a[56:59], v[8:11]
v_exp_f32 v26, v26
v_mfma_f32_16x16x32_bf16 v[8:11], a[108:111], a[60:63], v[8:11]
v_exp_f32 v27, v27
s_waitcnt lgkmcnt(0)
v_accvgpr_read_b32 v6, a165
v_cmp_nle_f32 vcc, v6, s48
v_mfma_f32_16x16x32_bf16 v[12:15], a[112:115], a[48:51], v[44:47]
v_exp_f32 v28, v28
v_rcp_f32 v6, v6
s_or_b64 s[52:53], s[52:53], vcc
v_mov_b32 v7, v6
v_mfma_f32_16x16x32_bf16 v[12:15], a[116:119], a[52:55], v[12:15]
v_exp_f32 v29, v29
v_pk_mul_f32 v[64:65], v[64:65], v[6:7]
v_pk_mul_f32 v[66:67], v[66:67], v[6:7]
v_cvt_pk_bf16_f32 v64, v64, v65
v_mfma_f32_16x16x32_bf16 v[12:15], a[120:123], a[56:59], v[12:15]
v_exp_f32 v30, v30
v_cvt_pk_bf16_f32 v65, v66, v67
v_pk_mul_f32 v[68:69], v[68:69], v[6:7]
v_pk_mul_f32 v[70:71], v[70:71], v[6:7]
v_mfma_f32_16x16x32_bf16 v[12:15], a[124:127], a[60:63], v[12:15]
ds_write_b64 v4, v[64:65] offset:0
v_exp_f32 v31, v31
v_cvt_pk_bf16_f32 v68, v68, v69
v_cvt_pk_bf16_f32 v69, v70, v71
v_pk_mul_f32 v[72:73], v[72:73], v[6:7]
v_mfma_f32_16x16x32_bf16 a[168:171], a[160:163], v[16:19], a[168:171]
ds_write_b64 v4, v[68:69] offset:32
v_cvt_pk_bf16_f32 v24, v24, v25
v_cvt_pk_bf16_f32 v25, v26, v27
v_pk_mul_f32 v[74:75], v[74:75], v[6:7]
v_cvt_pk_bf16_f32 v72, v72, v73
v_cvt_pk_bf16_f32 v73, v74, v75
v_mfma_f32_16x16x32_bf16 v[96:99], a[128:131], v[16:19], v[96:99]
ds_write_b64 v4, v[72:73] offset:64
v_cvt_pk_bf16_f32 v26, v28, v29
v_pk_mul_f32 v[76:77], v[76:77], v[6:7]
v_pk_mul_f32 v[78:79], v[78:79], v[6:7]
v_cvt_pk_bf16_f32 v76, v76, v77
v_mfma_f32_16x16x32_bf16 v[100:103], a[132:135], v[16:19], v[100:103]
v_cvt_pk_bf16_f32 v27, v30, v31
v_cvt_pk_bf16_f32 v77, v78, v79
v_pk_mul_f32 v[80:81], v[80:81], v[6:7]
v_pk_mul_f32 v[82:83], v[82:83], v[6:7]
v_mfma_f32_16x16x32_bf16 v[104:107], a[136:139], v[16:19], v[104:107]
ds_write_b64 v4, v[76:77] offset:96
v_cvt_pk_bf16_f32 v80, v80, v81
v_cvt_pk_bf16_f32 v81, v82, v83
v_pk_mul_f32 v[84:85], v[84:85], v[6:7]
v_mfma_f32_16x16x32_bf16 v[108:111], a[140:143], v[16:19], v[108:111]
ds_write_b64 v4, v[80:81] offset:128
v_pk_mul_f32 v[86:87], v[86:87], v[6:7]
v_cvt_pk_bf16_f32 v84, v84, v85
v_cvt_pk_bf16_f32 v85, v86, v87
v_mfma_f32_16x16x32_bf16 v[112:115], a[144:147], v[16:19], v[112:115]
ds_write_b64 v4, v[84:85] offset:160
v_pk_mul_f32 v[88:89], v[88:89], v[6:7]
v_pk_mul_f32 v[90:91], v[90:91], v[6:7]
v_cvt_pk_bf16_f32 v88, v88, v89
v_mfma_f32_16x16x32_bf16 v[116:119], a[148:151], v[16:19], v[116:119]
v_cvt_pk_bf16_f32 v89, v90, v91
v_pk_mul_f32 v[92:93], v[92:93], v[6:7]
v_pk_mul_f32 v[94:95], v[94:95], v[6:7]
v_mfma_f32_16x16x32_bf16 v[120:123], a[152:155], v[16:19], v[120:123]
ds_write_b64 v4, v[88:89] offset:192
v_cvt_pk_bf16_f32 v92, v92, v93
v_cvt_pk_bf16_f32 v93, v94, v95
v_mfma_f32_16x16x32_bf16 v[124:127], a[156:159], v[16:19], v[124:127]
ds_bpermute_b32 a169, v58, a168
v_mfma_f32_16x16x32_bf16 v[16:19], a[96:99], a[64:67], v[48:51]
ds_write_b64 v4, v[92:93] offset:224
ds_read_b128 v[64:67], v5 offset:0
v_exp_f32 v8, v8
v_mfma_f32_16x16x32_bf16 v[16:19], a[100:103], a[68:71], v[16:19]
ds_read_b128 v[68:71], v5 offset:1088
ds_read_b128 v[72:75], v5 offset:2176
v_exp_f32 v9, v9
v_mfma_f32_16x16x32_bf16 v[16:19], a[104:107], a[72:75], v[16:19]
ds_read_b128 v[76:79], v5 offset:3264
v_exp_f32 v10, v10
v_mfma_f32_16x16x32_bf16 v[16:19], a[108:111], a[76:79], v[16:19]
v_exp_f32 v11, v11
s_waitcnt lgkmcnt(5)
v_accvgpr_read_b32 v6, a169
v_cmp_nle_f32 vcc, v6, s48
v_mfma_f32_16x16x32_bf16 v[20:23], a[112:115], a[64:67], v[48:51]
v_exp_f32 v12, v12
v_rcp_f32 v6, v6
s_or_b64 s[52:53], s[52:53], vcc
v_mov_b32 v7, v6
v_mfma_f32_16x16x32_bf16 v[20:23], a[116:119], a[68:71], v[20:23]
v_exp_f32 v13, v13
v_pk_mul_f32 v[96:97], v[96:97], v[6:7]
v_pk_mul_f32 v[98:99], v[98:99], v[6:7]
v_cvt_pk_bf16_f32 v96, v96, v97
v_mfma_f32_16x16x32_bf16 v[20:23], a[120:123], a[72:75], v[20:23]
v_exp_f32 v14, v14
v_cvt_pk_bf16_f32 v97, v98, v99
v_pk_mul_f32 v[100:101], v[100:101], v[6:7]
v_pk_mul_f32 v[102:103], v[102:103], v[6:7]
v_mfma_f32_16x16x32_bf16 v[20:23], a[124:127], a[76:79], v[20:23]
ds_write_b64 v4, v[96:97] offset:4352
v_exp_f32 v15, v15
v_cvt_pk_bf16_f32 v100, v100, v101
v_cvt_pk_bf16_f32 v101, v102, v103
v_pk_mul_f32 v[104:105], v[104:105], v[6:7]
v_mfma_f32_16x16x32_bf16 a[172:175], a[160:163], v[24:27], a[172:175]
s_waitcnt lgkmcnt(1)
buffer_store_dwordx4 v[64:67], v3, s[24:27], 0 offen offset:0 nt
v_cvt_pk_bf16_f32 v8, v8, v9
v_cvt_pk_bf16_f32 v9, v10, v11
v_pk_mul_f32 v[106:107], v[106:107], v[6:7]
v_cvt_pk_bf16_f32 v104, v104, v105
v_cvt_pk_bf16_f32 v105, v106, v107
v_mfma_f32_16x16x32_bf16 v[128:131], a[128:131], v[24:27], v[128:131]
buffer_store_dwordx4 v[68:71], v3, s[24:27], 0 offen offset:1024 nt
v_cvt_pk_bf16_f32 v10, v12, v13
v_pk_mul_f32 v[108:109], v[108:109], v[6:7]
v_pk_mul_f32 v[110:111], v[110:111], v[6:7]
v_cvt_pk_bf16_f32 v108, v108, v109
v_mfma_f32_16x16x32_bf16 v[132:135], a[132:135], v[24:27], v[132:135]
buffer_store_dwordx4 v[72:75], v3, s[24:27], 0 offen offset:2048 nt
v_cvt_pk_bf16_f32 v11, v14, v15
v_cvt_pk_bf16_f32 v109, v110, v111
v_pk_mul_f32 v[112:113], v[112:113], v[6:7]
v_pk_mul_f32 v[114:115], v[114:115], v[6:7]
v_mfma_f32_16x16x32_bf16 v[136:139], a[136:139], v[24:27], v[136:139]
buffer_store_dwordx4 v[76:79], v3, s[24:27], 0 offen offset:3072 nt
v_cvt_pk_bf16_f32 v112, v112, v113
v_cvt_pk_bf16_f32 v113, v114, v115
v_pk_mul_f32 v[116:117], v[116:117], v[6:7]
v_mfma_f32_16x16x32_bf16 v[140:143], a[140:143], v[24:27], v[140:143]
ds_write_b64 v4, v[100:101] offset:4384
v_pk_mul_f32 v[118:119], v[118:119], v[6:7]
v_cvt_pk_bf16_f32 v116, v116, v117
v_cvt_pk_bf16_f32 v117, v118, v119
v_mfma_f32_16x16x32_bf16 v[144:147], a[144:147], v[24:27], v[144:147]
ds_write_b64 v4, v[104:105] offset:4416
v_pk_mul_f32 v[120:121], v[120:121], v[6:7]
v_pk_mul_f32 v[122:123], v[122:123], v[6:7]
v_cvt_pk_bf16_f32 v120, v120, v121
v_mfma_f32_16x16x32_bf16 v[148:151], a[148:151], v[24:27], v[148:151]
ds_write_b64 v4, v[108:109] offset:4448
v_cvt_pk_bf16_f32 v121, v122, v123
v_pk_mul_f32 v[124:125], v[124:125], v[6:7]
v_pk_mul_f32 v[126:127], v[126:127], v[6:7]
v_mfma_f32_16x16x32_bf16 v[152:155], a[152:155], v[24:27], v[152:155]
ds_write_b64 v4, v[112:113] offset:4480
v_cvt_pk_bf16_f32 v124, v124, v125
v_cvt_pk_bf16_f32 v125, v126, v127
v_mfma_f32_16x16x32_bf16 v[156:159], a[156:159], v[24:27], v[156:159]
ds_bpermute_b32 a173, v58, a172
v_mfma_f32_16x16x32_bf16 v[24:27], a[96:99], a[80:83], v[52:55]
ds_write_b64 v4, v[116:117] offset:4512
v_exp_f32 v16, v16
v_mfma_f32_16x16x32_bf16 v[24:27], a[100:103], a[84:87], v[24:27]
ds_write_b64 v4, v[120:121] offset:4544
v_exp_f32 v17, v17
v_mfma_f32_16x16x32_bf16 v[24:27], a[104:107], a[88:91], v[24:27]
ds_write_b64 v4, v[124:125] offset:4576
ds_read_b128 v[96:99], v5 offset:4352
v_exp_f32 v18, v18
v_mfma_f32_16x16x32_bf16 v[24:27], a[108:111], a[92:95], v[24:27]
ds_read_b128 v[100:103], v5 offset:5440
ds_read_b128 v[104:107], v5 offset:6528
v_exp_f32 v19, v19
s_waitcnt lgkmcnt(6)
v_accvgpr_read_b32 v6, a173
v_cmp_nle_f32 vcc, v6, s48
v_mfma_f32_16x16x32_bf16 v[28:31], a[112:115], a[80:83], v[52:55]
ds_read_b128 v[108:111], v5 offset:7616
v_exp_f32 v20, v20
v_rcp_f32 v6, v6
s_or_b64 s[52:53], s[52:53], vcc
v_mov_b32 v7, v6
v_mfma_f32_16x16x32_bf16 v[28:31], a[116:119], a[84:87], v[28:31]
v_exp_f32 v21, v21
v_pk_mul_f32 v[128:129], v[128:129], v[6:7]
v_pk_mul_f32 v[130:131], v[130:131], v[6:7]
v_cvt_pk_bf16_f32 v128, v128, v129
v_mfma_f32_16x16x32_bf16 v[28:31], a[120:123], a[88:91], v[28:31]
v_exp_f32 v22, v22
v_cvt_pk_bf16_f32 v129, v130, v131
v_pk_mul_f32 v[132:133], v[132:133], v[6:7]
v_pk_mul_f32 v[134:135], v[134:135], v[6:7]
v_mfma_f32_16x16x32_bf16 v[28:31], a[124:127], a[92:95], v[28:31]
ds_write_b64 v4, v[128:129] offset:8704
v_exp_f32 v23, v23
v_cvt_pk_bf16_f32 v132, v132, v133
v_cvt_pk_bf16_f32 v133, v134, v135
v_pk_mul_f32 v[136:137], v[136:137], v[6:7]
v_mfma_f32_16x16x32_bf16 a[176:179], a[160:163], v[8:11], a[176:179]
ds_write_b64 v4, v[132:133] offset:8736
v_cvt_pk_bf16_f32 v16, v16, v17
v_cvt_pk_bf16_f32 v17, v18, v19
v_pk_mul_f32 v[138:139], v[138:139], v[6:7]
v_cvt_pk_bf16_f32 v136, v136, v137
v_cvt_pk_bf16_f32 v137, v138, v139
v_mfma_f32_16x16x32_bf16 v[160:163], a[128:131], v[8:11], v[160:163]
ds_write_b64 v4, v[136:137] offset:8768
v_cvt_pk_bf16_f32 v18, v20, v21
v_pk_mul_f32 v[140:141], v[140:141], v[6:7]
v_pk_mul_f32 v[142:143], v[142:143], v[6:7]
v_cvt_pk_bf16_f32 v140, v140, v141
v_mfma_f32_16x16x32_bf16 v[164:167], a[132:135], v[8:11], v[164:167]
s_waitcnt lgkmcnt(3)
buffer_store_dwordx4 v[96:99], v3, s[24:27], s84 offen offset:0 nt
v_cvt_pk_bf16_f32 v19, v22, v23
v_cvt_pk_bf16_f32 v141, v142, v143
v_pk_mul_f32 v[144:145], v[144:145], v[6:7]
v_pk_mul_f32 v[146:147], v[146:147], v[6:7]
v_mfma_f32_16x16x32_bf16 v[168:171], a[136:139], v[8:11], v[168:171]
buffer_store_dwordx4 v[100:103], v3, s[24:27], s84 offen offset:1024 nt
v_cvt_pk_bf16_f32 v144, v144, v145
v_cvt_pk_bf16_f32 v145, v146, v147
v_pk_mul_f32 v[148:149], v[148:149], v[6:7]
v_mfma_f32_16x16x32_bf16 v[172:175], a[140:143], v[8:11], v[172:175]
buffer_store_dwordx4 v[104:107], v3, s[24:27], s84 offen offset:2048 nt
v_pk_mul_f32 v[150:151], v[150:151], v[6:7]
v_cvt_pk_bf16_f32 v148, v148, v149
v_cvt_pk_bf16_f32 v149, v150, v151
v_mfma_f32_16x16x32_bf16 v[176:179], a[144:147], v[8:11], v[176:179]
buffer_store_dwordx4 v[108:111], v3, s[24:27], s84 offen offset:3072 nt
v_pk_mul_f32 v[152:153], v[152:153], v[6:7]
v_pk_mul_f32 v[154:155], v[154:155], v[6:7]
v_cvt_pk_bf16_f32 v152, v152, v153
v_mfma_f32_16x16x32_bf16 v[180:183], a[148:151], v[8:11], v[180:183]
ds_write_b64 v4, v[140:141] offset:8800
v_cvt_pk_bf16_f32 v153, v154, v155
v_pk_mul_f32 v[156:157], v[156:157], v[6:7]
v_pk_mul_f32 v[158:159], v[158:159], v[6:7]
v_mfma_f32_16x16x32_bf16 v[184:187], a[152:155], v[8:11], v[184:187]
ds_write_b64 v4, v[144:145] offset:8832
v_cvt_pk_bf16_f32 v156, v156, v157
v_cvt_pk_bf16_f32 v157, v158, v159
v_mfma_f32_16x16x32_bf16 v[188:191], a[156:159], v[8:11], v[188:191]
ds_bpermute_b32 a177, v58, a176
ds_write_b64 v4, v[148:149] offset:8864
v_exp_f32 v24, v24
ds_write_b64 v4, v[152:153] offset:8896
v_exp_f32 v25, v25
ds_write_b64 v4, v[156:157] offset:8928
ds_read_b128 v[128:131], v5 offset:8704
v_exp_f32 v26, v26
ds_read_b128 v[132:135], v5 offset:9792
ds_read_b128 v[136:139], v5 offset:10880
v_exp_f32 v27, v27
s_waitcnt lgkmcnt(6)
v_accvgpr_read_b32 v6, a177
v_cmp_nle_f32 vcc, v6, s48
ds_read_b128 v[140:143], v5 offset:11968
v_exp_f32 v28, v28
v_rcp_f32 v6, v6
s_or_b64 s[52:53], s[52:53], vcc
v_mov_b32 v7, v6
v_exp_f32 v29, v29
v_pk_mul_f32 v[160:161], v[160:161], v[6:7]
v_pk_mul_f32 v[162:163], v[162:163], v[6:7]
v_cvt_pk_bf16_f32 v160, v160, v161
v_exp_f32 v30, v30
v_cvt_pk_bf16_f32 v161, v162, v163
v_pk_mul_f32 v[164:165], v[164:165], v[6:7]
v_pk_mul_f32 v[166:167], v[166:167], v[6:7]
ds_write_b64 v4, v[160:161] offset:0
v_exp_f32 v31, v31
v_cvt_pk_bf16_f32 v164, v164, v165
v_cvt_pk_bf16_f32 v165, v166, v167
v_pk_mul_f32 v[168:169], v[168:169], v[6:7]
v_mfma_f32_16x16x32_bf16 a[180:183], a[160:163], v[16:19], a[180:183]
ds_write_b64 v4, v[164:165] offset:32
v_cvt_pk_bf16_f32 v24, v24, v25
v_cvt_pk_bf16_f32 v25, v26, v27
v_pk_mul_f32 v[170:171], v[170:171], v[6:7]
v_cvt_pk_bf16_f32 v168, v168, v169
v_cvt_pk_bf16_f32 v169, v170, v171
v_mfma_f32_16x16x32_bf16 v[192:195], a[128:131], v[16:19], v[192:195]
ds_write_b64 v4, v[168:169] offset:64
v_cvt_pk_bf16_f32 v26, v28, v29
v_pk_mul_f32 v[172:173], v[172:173], v[6:7]
v_pk_mul_f32 v[174:175], v[174:175], v[6:7]
v_cvt_pk_bf16_f32 v172, v172, v173
v_mfma_f32_16x16x32_bf16 v[196:199], a[132:135], v[16:19], v[196:199]
s_waitcnt lgkmcnt(3)
buffer_store_dwordx4 v[128:131], v3, s[24:27], s85 offen offset:0 nt
v_cvt_pk_bf16_f32 v27, v30, v31
v_cvt_pk_bf16_f32 v173, v174, v175
v_pk_mul_f32 v[176:177], v[176:177], v[6:7]
v_pk_mul_f32 v[178:179], v[178:179], v[6:7]
v_mfma_f32_16x16x32_bf16 v[200:203], a[136:139], v[16:19], v[200:203]
buffer_store_dwordx4 v[132:135], v3, s[24:27], s85 offen offset:1024 nt
v_cvt_pk_bf16_f32 v176, v176, v177
v_cvt_pk_bf16_f32 v177, v178, v179
v_pk_mul_f32 v[180:181], v[180:181], v[6:7]
v_mfma_f32_16x16x32_bf16 v[204:207], a[140:143], v[16:19], v[204:207]
buffer_store_dwordx4 v[136:139], v3, s[24:27], s85 offen offset:2048 nt
v_pk_mul_f32 v[182:183], v[182:183], v[6:7]
v_cvt_pk_bf16_f32 v180, v180, v181
v_cvt_pk_bf16_f32 v181, v182, v183
v_mfma_f32_16x16x32_bf16 v[208:211], a[144:147], v[16:19], v[208:211]
buffer_store_dwordx4 v[140:143], v3, s[24:27], s85 offen offset:3072 nt
v_pk_mul_f32 v[184:185], v[184:185], v[6:7]
v_pk_mul_f32 v[186:187], v[186:187], v[6:7]
v_cvt_pk_bf16_f32 v184, v184, v185
v_mfma_f32_16x16x32_bf16 v[212:215], a[148:151], v[16:19], v[212:215]
ds_write_b64 v4, v[172:173] offset:96
v_cvt_pk_bf16_f32 v185, v186, v187
v_pk_mul_f32 v[188:189], v[188:189], v[6:7]
v_pk_mul_f32 v[190:191], v[190:191], v[6:7]
v_mfma_f32_16x16x32_bf16 v[216:219], a[152:155], v[16:19], v[216:219]
ds_write_b64 v4, v[176:177] offset:128
v_cvt_pk_bf16_f32 v188, v188, v189
v_cvt_pk_bf16_f32 v189, v190, v191
v_mfma_f32_16x16x32_bf16 v[220:223], a[156:159], v[16:19], v[220:223]
ds_bpermute_b32 a181, v58, a180
v_mfma_f32_16x16x32_bf16 a[184:187], a[160:163], v[24:27], a[184:187]
ds_write_b64 v4, v[180:181] offset:160
v_mfma_f32_16x16x32_bf16 v[224:227], a[128:131], v[24:27], v[224:227]
ds_write_b64 v4, v[184:185] offset:192
v_mfma_f32_16x16x32_bf16 v[228:231], a[132:135], v[24:27], v[228:231]
ds_write_b64 v4, v[188:189] offset:224
ds_read_b128 v[160:163], v5 offset:0
v_mfma_f32_16x16x32_bf16 v[232:235], a[136:139], v[24:27], v[232:235]
ds_read_b128 v[164:167], v5 offset:1088
ds_read_b128 v[168:171], v5 offset:2176
s_waitcnt lgkmcnt(6)
v_accvgpr_read_b32 v6, a181
v_cmp_nle_f32 vcc, v6, s48
v_mfma_f32_16x16x32_bf16 v[236:239], a[140:143], v[24:27], v[236:239]
ds_read_b128 v[172:175], v5 offset:3264
v_rcp_f32 v6, v6
s_or_b64 s[52:53], s[52:53], vcc
v_mov_b32 v7, v6
v_mfma_f32_16x16x32_bf16 v[240:243], a[144:147], v[24:27], v[240:243]
v_pk_mul_f32 v[192:193], v[192:193], v[6:7]
v_pk_mul_f32 v[194:195], v[194:195], v[6:7]
v_cvt_pk_bf16_f32 v192, v192, v193
v_mfma_f32_16x16x32_bf16 v[244:247], a[148:151], v[24:27], v[244:247]
v_cvt_pk_bf16_f32 v193, v194, v195
v_pk_mul_f32 v[196:197], v[196:197], v[6:7]
v_pk_mul_f32 v[198:199], v[198:199], v[6:7]
v_mfma_f32_16x16x32_bf16 v[248:251], a[152:155], v[24:27], v[248:251]
ds_write_b64 v4, v[192:193] offset:4352
v_cvt_pk_bf16_f32 v196, v196, v197
v_cvt_pk_bf16_f32 v197, v198, v199
v_pk_mul_f32 v[200:201], v[200:201], v[6:7]
v_mfma_f32_16x16x32_bf16 v[252:255], a[156:159], v[24:27], v[252:255]
ds_bpermute_b32 a185, v58, a184
v_pk_mul_f32 v[202:203], v[202:203], v[6:7]
v_cvt_pk_bf16_f32 v200, v200, v201
v_cvt_pk_bf16_f32 v201, v202, v203
ds_write_b64 v4, v[196:197] offset:4384
ds_write_b64 v4, v[200:201] offset:4416
v_pk_mul_f32 v[204:205], v[204:205], v[6:7]
v_pk_mul_f32 v[206:207], v[206:207], v[6:7]
v_cvt_pk_bf16_f32 v204, v204, v205
v_cvt_pk_bf16_f32 v205, v206, v207
v_pk_mul_f32 v[208:209], v[208:209], v[6:7]
v_pk_mul_f32 v[210:211], v[210:211], v[6:7]
v_cvt_pk_bf16_f32 v208, v208, v209
v_cvt_pk_bf16_f32 v209, v210, v211
ds_write_b64 v4, v[204:205] offset:4448
ds_write_b64 v4, v[208:209] offset:4480
v_pk_mul_f32 v[212:213], v[212:213], v[6:7]
v_pk_mul_f32 v[214:215], v[214:215], v[6:7]
v_cvt_pk_bf16_f32 v212, v212, v213
v_cvt_pk_bf16_f32 v213, v214, v215
v_pk_mul_f32 v[216:217], v[216:217], v[6:7]
v_pk_mul_f32 v[218:219], v[218:219], v[6:7]
v_cvt_pk_bf16_f32 v216, v216, v217
v_cvt_pk_bf16_f32 v217, v218, v219
ds_write_b64 v4, v[212:213] offset:4512
ds_write_b64 v4, v[216:217] offset:4544
v_pk_mul_f32 v[220:221], v[220:221], v[6:7]
v_pk_mul_f32 v[222:223], v[222:223], v[6:7]
v_cvt_pk_bf16_f32 v220, v220, v221
v_cvt_pk_bf16_f32 v221, v222, v223
ds_write_b64 v4, v[220:221] offset:4576
ds_read_b128 v[192:195], v5 offset:4352
ds_read_b128 v[196:199], v5 offset:5440
ds_read_b128 v[200:203], v5 offset:6528
ds_read_b128 v[204:207], v5 offset:7616
s_waitcnt lgkmcnt(11)
v_accvgpr_read_b32 v6, a185
v_cmp_nle_f32 vcc, v6, s48
v_rcp_f32 v6, v6
s_or_b64 s[52:53], s[52:53], vcc
v_mov_b32 v7, v6
v_pk_mul_f32 v[224:225], v[224:225], v[6:7]
v_pk_mul_f32 v[226:227], v[226:227], v[6:7]
s_waitcnt lgkmcnt(13)
buffer_store_dwordx4 v[160:163], v3, s[24:27], s86 offen offset:0 nt
v_cvt_pk_bf16_f32 v224, v224, v225
v_cvt_pk_bf16_f32 v225, v226, v227
v_pk_mul_f32 v[228:229], v[228:229], v[6:7]
v_pk_mul_f32 v[230:231], v[230:231], v[6:7]
v_cvt_pk_bf16_f32 v228, v228, v229
v_cvt_pk_bf16_f32 v229, v230, v231
v_pk_mul_f32 v[232:233], v[232:233], v[6:7]
v_pk_mul_f32 v[234:235], v[234:235], v[6:7]
ds_write_b64 v4, v[224:225] offset:8704
ds_write_b64 v4, v[228:229] offset:8736
buffer_store_dwordx4 v[164:167], v3, s[24:27], s86 offen offset:1024 nt
v_cvt_pk_bf16_f32 v232, v232, v233
v_cvt_pk_bf16_f32 v233, v234, v235
v_pk_mul_f32 v[236:237], v[236:237], v[6:7]
v_pk_mul_f32 v[238:239], v[238:239], v[6:7]
v_cvt_pk_bf16_f32 v236, v236, v237
v_cvt_pk_bf16_f32 v237, v238, v239
v_pk_mul_f32 v[240:241], v[240:241], v[6:7]
v_pk_mul_f32 v[242:243], v[242:243], v[6:7]
ds_write_b64 v4, v[232:233] offset:8768
ds_write_b64 v4, v[236:237] offset:8800
buffer_store_dwordx4 v[168:171], v3, s[24:27], s86 offen offset:2048 nt
v_cvt_pk_bf16_f32 v240, v240, v241
v_cvt_pk_bf16_f32 v241, v242, v243
v_pk_mul_f32 v[244:245], v[244:245], v[6:7]
v_pk_mul_f32 v[246:247], v[246:247], v[6:7]
v_cvt_pk_bf16_f32 v244, v244, v245
v_cvt_pk_bf16_f32 v245, v246, v247
v_pk_mul_f32 v[248:249], v[248:249], v[6:7]
v_pk_mul_f32 v[250:251], v[250:251], v[6:7]
ds_write_b64 v4, v[240:241] offset:8832
ds_write_b64 v4, v[244:245] offset:8864
buffer_store_dwordx4 v[172:175], v3, s[24:27], s86 offen offset:3072 nt
v_cvt_pk_bf16_f32 v248, v248, v249
v_cvt_pk_bf16_f32 v249, v250, v251
v_pk_mul_f32 v[252:253], v[252:253], v[6:7]
v_pk_mul_f32 v[254:255], v[254:255], v[6:7]
v_cvt_pk_bf16_f32 v252, v252, v253
v_cvt_pk_bf16_f32 v253, v254, v255
ds_write_b64 v4, v[248:249] offset:8896
ds_write_b64 v4, v[252:253] offset:8928
ds_read_b128 v[224:227], v5 offset:8704
ds_read_b128 v[228:231], v5 offset:9792
ds_read_b128 v[232:235], v5 offset:10880
ds_read_b128 v[236:239], v5 offset:11968
s_waitcnt lgkmcnt(12)
buffer_store_dwordx4 v[192:195], v3, s[24:27], s87 offen offset:0 nt
buffer_store_dwordx4 v[196:199], v3, s[24:27], s87 offen offset:1024 nt
buffer_store_dwordx4 v[200:203], v3, s[24:27], s87 offen offset:2048 nt
buffer_store_dwordx4 v[204:207], v3, s[24:27], s87 offen offset:3072 nt
s_waitcnt lgkmcnt(0)
buffer_store_dwordx4 v[224:227], v3, s[24:27], s88 offen offset:0 nt
buffer_store_dwordx4 v[228:231], v3, s[24:27], s88 offen offset:1024 nt
buffer_store_dwordx4 v[232:235], v3, s[24:27], s88 offen offset:2048 nt
buffer_store_dwordx4 v[236:239], v3, s[24:27], s88 offen offset:3072 nt
s_cmp_lg_u64 s[52:53], 0
s_cbranch_scc1 L_fallback
L_done:
L_end:
s_endpgm
L_siteL_off:
v_mfma_f32_16x16x32_bf16 a[184:187], a[160:163], v[24:27], a[184:187]
v_cvt_pk_bf16_f32 v8, v8, v9
v_cvt_pk_bf16_f32 v9, v10, v11
v_mfma_f32_16x16x32_bf16 v[224:227], a[128:131], v[24:27], v[224:227]
ds_read_b64_tr_b16 a[128:129], v2 offset:0
ds_read_b64_tr_b16 a[130:131], v2 offset:512
v_cvt_pk_bf16_f32 v10, v12, v13
v_mfma_f32_16x16x32_bf16 v[228:231], a[132:135], v[24:27], v[228:231]
ds_read_b64_tr_b16 a[132:133], v2 offset:32
ds_read_b64_tr_b16 a[134:135], v2 offset:544
v_cvt_pk_bf16_f32 v11, v14, v15
v_mfma_f32_16x16x32_bf16 v[232:235], a[136:139], v[24:27], v[232:235]
ds_read_b64_tr_b16 a[136:137], v2 offset:64
ds_read_b64_tr_b16 a[138:139], v2 offset:576
v_mfma_f32_16x16x32_bf16 v[236:239], a[140:143], v[24:27], v[236:239]
ds_read_b64_tr_b16 a[140:141], v2 offset:96
ds_read_b64_tr_b16 a[142:143], v2 offset:608
v_mfma_f32_16x16x32_bf16 v[240:243], a[144:147], v[24:27], v[240:243]
ds_read_b64_tr_b16 a[144:145], v2 offset:128
ds_read_b64_tr_b16 a[146:147], v2 offset:640
v_mfma_f32_16x16x32_bf16 v[244:247], a[148:151], v[24:27], v[244:247]
ds_read_b64_tr_b16 a[148:149], v2 offset:160
ds_read_b64_tr_b16 a[150:151], v2 offset:672
v_mfma_f32_16x16x32_bf16 v[248:251], a[152:155], v[24:27], v[248:251]
ds_read_b64_tr_b16 a[152:153], v2 offset:192
ds_read_b64_tr_b16 a[154:155], v2 offset:704
v_mfma_f32_16x16x32_bf16 v[252:255], a[156:159], v[24:27], v[252:255]
ds_read_b64_tr_b16 a[156:157], v2 offset:224
ds_read_b64_tr_b16 a[158:159], v2 offset:736
s_branch L_siteL_join
L_siteE_on:
v_mfma_f32_16x16x32_bf16 a[176:179], a[160:163], v[8:11], a[176:179]
s_add_u32 m0, s43, 8448
v_cvt_pk_bf16_f32 v16, v16, v17
v_cvt_pk_bf16_f32 v17, v18, v19
v_mfma_f32_16x16x32_bf16 v[160:163], a[128:131], v[8:11], v[160:163]
buffer_load_dwordx4 v3, s[16:19], 0 offen offset:0 nt lds
s_add_u32 m0, m0, 32
v_cvt_pk_bf16_f32 v18, v20, v21
v_mfma_f32_16x16x32_bf16 v[164:167], a[132:135], v[8:11], v[164:167]
buffer_load_dwordx4 v3, s[16:19], 0 offen offset:1024 nt lds
s_add_u32 m0, m0, 32
v_cvt_pk_bf16_f32 v19, v22, v23
v_mfma_f32_16x16x32_bf16 v[168:171], a[136:139], v[8:11], v[168:171]
buffer_load_dwordx4 v3, s[16:19], 0 offen offset:2048 nt lds
s_add_u32 m0, m0, 32
v_mfma_f32_16x16x32_bf16 v[172:175], a[140:143], v[8:11], v[172:175]
buffer_load_dwordx4 v3, s[16:19], 0 offen offset:3072 nt lds
s_mov_b32 m0, s43
v_mfma_f32_16x16x32_bf16 v[176:179], a[144:147], v[8:11], v[176:179]
buffer_load_dwordx4 v3, s[20:23], 0 offen offset:0 nt lds
s_add_u32 m0, m0, 32
v_mfma_f32_16x16x32_bf16 v[180:183], a[148:151], v[8:11], v[180:183]
buffer_load_dwordx4 v3, s[20:23], 0 offen offset:1024 nt lds
s_add_u32 m0, m0, 32
v_mfma_f32_16x16x32_bf16 v[184:187], a[152:155], v[8:11], v[184:187]
buffer_load_dwordx4 v3, s[20:23], 0 offen offset:2048 nt lds
s_add_u32 m0, m0, 32
v_mfma_f32_16x16x32_bf16 v[188:191], a[156:159], v[8:11], v[188:191]
buffer_load_dwordx4 v3, s[20:23], 0 offen offset:3072 nt lds
v_add_u32 v3, 0x2000, v3
s_add_u32 s43, s43, 16896
s_cmp_ge_u32 s43, s42
s_cselect_b32 s43, s40, s43
s_branch L_siteE_join
L_fallback:
s_waitcnt vmcnt(0)
v_subrev_u32 v1, s45, v1
v_subrev_u32 v2, s45, v2
v_add_u32 v1, s47, v1
v_add_u32 v2, s47, v2
v_mov_b32 v64, 0
v_mov_b32 v65, 0
v_mov_b32 v66, 0
v_mov_b32 v67, 0
v_mov_b32 v68, 0
v_mov_b32 v69, 0
v_mov_b32 v70, 0
v_mov_b32 v71, 0
v_mov_b32 v72, 0
v_mov_b32 v73, 0
v_mov_b32 v74, 0
v_mov_b32 v75, 0
v_mov_b32 v76, 0
v_mov_b32 v77, 0
v_mov_b32 v78, 0
v_mov_b32 v79, 0
v_mov_b32 v80, 0
v_mov_b32 v81, 0
v_mov_b32 v82, 0
v_mov_b32 v83, 0
v_mov_b32 v84, 0
v_mov_b32 v85, 0
v_mov_b32 v86, 0
v_mov_b32 v87, 0
v_mov_b32 v88, 0
v_mov_b32 v89, 0
v_mov_b32 v90, 0
v_mov_b32 v91, 0
v_mov_b32 v92, 0
v_mov_b32 v93, 0
v_mov_b32 v94, 0
v_mov_b32 v95, 0
v_mov_b32 v96, 0
v_mov_b32 v97, 0
v_mov_b32 v98, 0
v_mov_b32 v99, 0
v_mov_b32 v100, 0
v_mov_b32 v101, 0
v_mov_b32 v102, 0
v_mov_b32 v103, 0
v_mov_b32 v104, 0
v_mov_b32 v105, 0
v_mov_b32 v106, 0
v_mov_b32 v107, 0
v_mov_b32 v108, 0
v_mov_b32 v109, 0
v_mov_b32 v110, 0
v_mov_b32 v111, 0
v_mov_b32 v112, 0
v_mov_b32 v113, 0
v_mov_b32 v114, 0
v_mov_b32 v115, 0
v_mov_b32 v116, 0
v_mov_b32 v117, 0
v_mov_b32 v118, 0
v_mov_b32 v119, 0
v_mov_b32 v120, 0
v_mov_b32 v121, 0
v_mov_b32 v122, 0
v_mov_b32 v123, 0
v_mov_b32 v124, 0
v_mov_b32 v125, 0
v_mov_b32 v126, 0
v_mov_b32 v127, 0
v_mov_b32 v128, 0
v_mov_b32 v129, 0
v_mov_b32 v130, 0
v_mov_b32 v131, 0
v_mov_b32 v132, 0
v_mov_b32 v133, 0
v_mov_b32 v134, 0
v_mov_b32 v135, 0
v_mov_b32 v136, 0
v_mov_b32 v137, 0
v_mov_b32 v138, 0
v_mov_b32 v139, 0
v_mov_b32 v140, 0
v_mov_b32 v141, 0
v_mov_b32 v142, 0
v_mov_b32 v143, 0
v_mov_b32 v144, 0
v_mov_b32 v145, 0
v_mov_b32 v146, 0
v_mov_b32 v147, 0
v_mov_b32 v148, 0
v_mov_b32 v149, 0
v_mov_b32 v150, 0
v_mov_b32 v151, 0
v_mov_b32 v152, 0
v_mov_b32 v153, 0
v_mov_b32 v154, 0
v_mov_b32 v155, 0
v_mov_b32 v156, 0
v_mov_b32 v157, 0
v_mov_b32 v158, 0
v_mov_b32 v159, 0
v_mov_b32 v160, 0
v_mov_b32 v161, 0
v_mov_b32 v162, 0
v_mov_b32 v163, 0
v_mov_b32 v164, 0
v_mov_b32 v165, 0
v_mov_b32 v166, 0
v_mov_b32 v167, 0
v_mov_b32 v168, 0
v_mov_b32 v169, 0
v_mov_b32 v170, 0
v_mov_b32 v171, 0
v_mov_b32 v172, 0
v_mov_b32 v173, 0
v_mov_b32 v174, 0
v_mov_b32 v175, 0
v_mov_b32 v176, 0
v_mov_b32 v177, 0
v_mov_b32 v178, 0
v_mov_b32 v179, 0
v_mov_b32 v180, 0
v_mov_b32 v181, 0
v_mov_b32 v182, 0
v_mov_b32 v183, 0
v_mov_b32 v184, 0
v_mov_b32 v185, 0
v_mov_b32 v186, 0
v_mov_b32 v187, 0
v_mov_b32 v188, 0
v_mov_b32 v189, 0
v_mov_b32 v190, 0
v_mov_b32 v191, 0
v_mov_b32 v192, 0
v_mov_b32 v193, 0
v_mov_b32 v194, 0
v_mov_b32 v195, 0
v_mov_b32 v196, 0
v_mov_b32 v197, 0
v_mov_b32 v198, 0
v_mov_b32 v199, 0
v_mov_b32 v200, 0
v_mov_b32 v201, 0
v_mov_b32 v202, 0
v_mov_b32 v203, 0
v_mov_b32 v204, 0
v_mov_b32 v205, 0
v_mov_b32 v206, 0
v_mov_b32 v207, 0
v_mov_b32 v208, 0
v_mov_b32 v209, 0
v_mov_b32 v210, 0
v_mov_b32 v211, 0
v_mov_b32 v212, 0
v_mov_b32 v213, 0
v_mov_b32 v214, 0
v_mov_b32 v215, 0
v_mov_b32 v216, 0
v_mov_b32 v217, 0
v_mov_b32 v218, 0
v_mov_b32 v219, 0
v_mov_b32 v220, 0
v_mov_b32 v221, 0
v_mov_b32 v222, 0
v_mov_b32 v223, 0
v_mov_b32 v224, 0
v_mov_b32 v225, 0
v_mov_b32 v226, 0
v_mov_b32 v227, 0
v_mov_b32 v228, 0
v_mov_b32 v229, 0
v_mov_b32 v230, 0
v_mov_b32 v231, 0
v_mov_b32 v232, 0
v_mov_b32 v233, 0
v_mov_b32 v234, 0
v_mov_b32 v235, 0
v_mov_b32 v236, 0
v_mov_b32 v237, 0
v_mov_b32 v238, 0
v_mov_b32 v239, 0
v_mov_b32 v240, 0
v_mov_b32 v241, 0
v_mov_b32 v242, 0
v_mov_b32 v243, 0
v_mov_b32 v244, 0
v_mov_b32 v245, 0
v_mov_b32 v246, 0
v_mov_b32 v247, 0
v_mov_b32 v248, 0
v_mov_b32 v249, 0
v_mov_b32 v250, 0
v_mov_b32 v251, 0
v_mov_b32 v252, 0
v_mov_b32 v253, 0
v_mov_b32 v254, 0
v_mov_b32 v255, 0
v_accvgpr_write_b32 a164, 0
v_accvgpr_write_b32 a165, 0
v_accvgpr_write_b32 a166, 0
v_accvgpr_write_b32 a167, 0
v_mov_b32 v32, 0xff800000
v_accvgpr_write_b32 a168, 0
v_accvgpr_write_b32 a169, 0
v_accvgpr_write_b32 a170, 0
v_accvgpr_write_b32 a171, 0
v_mov_b32 v33, 0xff800000
v_accvgpr_write_b32 a172, 0
v_accvgpr_write_b32 a173, 0
v_accvgpr_write_b32 a174, 0
v_accvgpr_write_b32 a175, 0
v_mov_b32 v34, 0xff800000
v_accvgpr_write_b32 a176, 0
v_accvgpr_write_b32 a177, 0
v_accvgpr_write_b32 a178, 0
v_accvgpr_write_b32 a179, 0
v_mov_b32 v35, 0xff800000
v_accvgpr_write_b32 a180, 0
v_accvgpr_write_b32 a181, 0
v_accvgpr_write_b32 a182, 0
v_accvgpr_write_b32 a183, 0
v_mov_b32 v36, 0xff800000
v_accvgpr_write_b32 a184, 0
v_accvgpr_write_b32 a185, 0
v_accvgpr_write_b32 a186, 0
v_accvgpr_write_b32 a187, 0
v_mov_b32 v37, 0xff800000
v_lshlrev_b32 v3, 4, v0
s_mov_b32 s44, 0
L_fb_loop:
s_add_u32 m0, s47, 8448
v_add_u32 v7, 0, v3
buffer_load_dwordx4 v7, s[16:19], 0 offen lds
s_add_u32 m0, s47, 9504
v_add_u32 v7, 1024, v3
buffer_load_dwordx4 v7, s[16:19], 0 offen lds
s_add_u32 m0, s47, 10560
v_add_u32 v7, 2048, v3
buffer_load_dwordx4 v7, s[16:19], 0 offen lds
s_add_u32 m0, s47, 11616
v_add_u32 v7, 3072, v3
buffer_load_dwordx4 v7, s[16:19], 0 offen lds
s_add_u32 m0, s47, 12672
v_add_u32 v7, 4096, v3
buffer_load_dwordx4 v7, s[16:19], 0 offen lds
s_add_u32 m0, s47, 13728
v_add_u32 v7, 5120, v3
buffer_load_dwordx4 v7, s[16:19], 0 offen lds
s_add_u32 m0, s47, 14784
v_add_u32 v7, 6144, v3
buffer_load_dwordx4 v7, s[16:19], 0 offen lds
s_add_u32 m0, s47, 15840
v_add_u32 v7, 7168, v3
buffer_load_dwordx4 v7, s[16:19], 0 offen lds
s_add_u32 m0, s47, 0
v_add_u32 v7, 0, v3
buffer_load_dwordx4 v7, s[20:23], 0 offen lds
s_add_u32 m0, s47, 1056
v_add_u32 v7, 1024, v3
buffer_load_dwordx4 v7, s[20:23], 0 offen lds
s_add_u32 m0, s47, 2112
v_add_u32 v7, 2048, v3
buffer_load_dwordx4 v7, s[20:23], 0 offen lds
s_add_u32 m0, s47, 3168
v_add_u32 v7, 3072, v3
buffer_load_dwordx4 v7, s[20:23], 0 offen lds
s_add_u32 m0, s47, 4224
v_add_u32 v7, 4096, v3
buffer_load_dwordx4 v7, s[20:23], 0 offen lds
s_add_u32 m0, s47, 5280
v_add_u32 v7, 5120, v3
buffer_load_dwordx4 v7, s[20:23], 0 offen lds
s_add_u32 m0, s47, 6336
v_add_u32 v7, 6144, v3
buffer_load_dwordx4 v7, s[20:23], 0 offen lds
s_add_u32 m0, s47, 7392
v_add_u32 v7, 7168, v3
buffer_load_dwordx4 v7, s[20:23], 0 offen lds
s_waitcnt vmcnt(0)
ds_read_b128 a[96:99], v1 offset:8448
ds_read_b128 a[100:103], v1 offset:8512
ds_read_b128 a[104:107], v1 offset:8576
ds_read_b128 a[108:111], v1 offset:8640
ds_read_b128 a[112:115], v1 offset:8960
ds_read_b128 a[116:119], v1 offset:9024
ds_read_b128 a[120:123], v1 offset:9088
ds_read_b128 a[124:127], v1 offset:9152
s_waitcnt lgkmcnt(0)
ds_read_b64_tr_b16 a[128:129], v2 offset:0
ds_read_b64_tr_b16 a[130:131], v2 offset:512
ds_read_b64_tr_b16 a[132:133], v2 offset:32
ds_read_b64_tr_b16 a[134:135], v2 offset:544
ds_read_b64_tr_b16 a[136:137], v2 offset:64
ds_read_b64_tr_b16 a[138:139], v2 offset:576
ds_read_b64_tr_b16 a[140:141], v2 offset:96
ds_read_b64_tr_b16 a[142:143], v2 offset:608
s_waitcnt lgkmcnt(0)
ds_read_b64_tr_b16 a[144:145], v2 offset:128
ds_read_b64_tr_b16 a[146:147], v2 offset:640
ds_read_b64_tr_b16 a[148:149], v2 offset:160
ds_read_b64_tr_b16 a[150:151], v2 offset:672
ds_read_b64_tr_b16 a[152:153], v2 offset:192
ds_read_b64_tr_b16 a[154:155], v2 offset:704
ds_read_b64_tr_b16 a[156:157], v2 offset:224
ds_read_b64_tr_b16 a[158:159], v2 offset:736
s_waitcnt lgkmcnt(0)
v_mfma_f32_16x16x32_bf16 v[8:11], a[96:99], a[0:3], 0
v_mfma_f32_16x16x32_bf16 v[8:11], a[100:103], a[4:7], v[8:11]
v_mfma_f32_16x16x32_bf16 v[8:11], a[104:107], a[8:11], v[8:11]
v_mfma_f32_16x16x32_bf16 v[8:11], a[108:111], a[12:15], v[8:11]
v_mfma_f32_16x16x32_bf16 v[12:15], a[112:115], a[0:3], 0
v_mfma_f32_16x16x32_bf16 v[12:15], a[116:119], a[4:7], v[12:15]
v_mfma_f32_16x16x32_bf16 v[12:15], a[120:123], a[8:11], v[12:15]
v_mfma_f32_16x16x32_bf16 v[12:15], a[124:127], a[12:15], v[12:15]
s_nop 7
v_max3_f32 v56, v8, v9, v10
v_max3_f32 v56, v56, v11, v12
v_max3_f32 v56, v56, v13, v14
v_max_f32 v56, v56, v15
v_mov_b32 v57, v56
s_nop 1
v_permlane16_swap_b32 v57, v56
s_nop 1
v_max_f32 v56, v56, v57
v_mov_b32 v57, v56
s_nop 1
v_permlane32_swap_b32 v57, v56
s_nop 1
v_max_f32 v56, v56, v57
v_max_f32 v56, v56, v32
v_sub_f32 v57, v32, v56
v_exp_f32 v57, v57
v_mov_b32 v32, v56
v_accvgpr_read_b32 v59, a164
v_mul_f32 v59, v59, v57
v_accvgpr_write_b32 a164, v59
v_mul_f32 v64, v64, v57
v_mul_f32 v65, v65, v57
v_mul_f32 v66, v66, v57
v_mul_f32 v67, v67, v57
v_mul_f32 v68, v68, v57
v_mul_f32 v69, v69, v57
v_mul_f32 v70, v70, v57
v_mul_f32 v71, v71, v57
v_mul_f32 v72, v72, v57
v_mul_f32 v73, v73, v57
v_mul_f32 v74, v74, v57
v_mul_f32 v75, v75, v57
v_mul_f32 v76, v76, v57
v_mul_f32 v77, v77, v57
v_mul_f32 v78, v78, v57
v_mul_f32 v79, v79, v57
v_mul_f32 v80, v80, v57
v_mul_f32 v81, v81, v57
v_mul_f32 v82, v82, v57
v_mul_f32 v83, v83, v57
v_mul_f32 v84, v84, v57
v_mul_f32 v85, v85, v57
v_mul_f32 v86, v86, v57
v_mul_f32 v87, v87, v57
v_mul_f32 v88, v88, v57
v_mul_f32 v89, v89, v57
v_mul_f32 v90, v90, v57
v_mul_f32 v91, v91, v57
v_mul_f32 v92, v92, v57
v_mul_f32 v93, v93, v57
v_mul_f32 v94, v94, v57
v_mul_f32 v95, v95, v57
v_sub_f32 v8, v8, v56
v_sub_f32 v9, v9, v56
v_sub_f32 v10, v10, v56
v_sub_f32 v11, v11, v56
v_sub_f32 v12, v12, v56
v_sub_f32 v13, v13, v56
v_sub_f32 v14, v14, v56
v_sub_f32 v15, v15, v56
v_exp_f32 v8, v8
v_exp_f32 v9, v9
v_exp_f32 v10, v10
v_exp_f32 v11, v11
v_exp_f32 v12, v12
v_exp_f32 v13, v13
v_exp_f32 v14, v14
v_exp_f32 v15, v15
s_nop 0
v_cvt_pk_bf16_f32 v8, v8, v9
v_cvt_pk_bf16_f32 v9, v10, v11
v_cvt_pk_bf16_f32 v10, v12, v13
v_cvt_pk_bf16_f32 v11, v14, v15
s_nop 1
v_mfma_f32_16x16x32_bf16 a[164:167], a[160:163], v[8:11], a[164:167]
v_mfma_f32_16x16x32_bf16 v[64:67], a[128:131], v[8:11], v[64:67]
v_mfma_f32_16x16x32_bf16 v[68:71], a[132:135], v[8:11], v[68:71]
v_mfma_f32_16x16x32_bf16 v[72:75], a[136:139], v[8:11], v[72:75]
v_mfma_f32_16x16x32_bf16 v[76:79], a[140:143], v[8:11], v[76:79]
v_mfma_f32_16x16x32_bf16 v[80:83], a[144:147], v[8:11], v[80:83]
v_mfma_f32_16x16x32_bf16 v[84:87], a[148:151], v[8:11], v[84:87]
v_mfma_f32_16x16x32_bf16 v[88:91], a[152:155], v[8:11], v[88:91]
v_mfma_f32_16x16x32_bf16 v[92:95], a[156:159], v[8:11], v[92:95]
v_mfma_f32_16x16x32_bf16 v[16:19], a[96:99], a[16:19], 0
v_mfma_f32_16x16x32_bf16 v[16:19], a[100:103], a[20:23], v[16:19]
v_mfma_f32_16x16x32_bf16 v[16:19], a[104:107], a[24:27], v[16:19]
v_mfma_f32_16x16x32_bf16 v[16:19], a[108:111], a[28:31], v[16:19]
v_mfma_f32_16x16x32_bf16 v[20:23], a[112:115], a[16:19], 0
v_mfma_f32_16x16x32_bf16 v[20:23], a[116:119], a[20:23], v[20:23]
v_mfma_f32_16x16x32_bf16 v[20:23], a[120:123], a[24:27], v[20:23]
v_mfma_f32_16x16x32_bf16 v[20:23], a[124:127], a[28:31], v[20:23]
s_nop 7
v_max3_f32 v56, v16, v17, v18
v_max3_f32 v56, v56, v19, v20
v_max3_f32 v56, v56, v21, v22
v_max_f32 v56, v56, v23
v_mov_b32 v57, v56
s_nop 1
v_permlane16_swap_b32 v57, v56
s_nop 1
v_max_f32 v56, v56, v57
v_mov_b32 v57, v56
s_nop 1
v_permlane32_swap_b32 v57, v56
s_nop 1
v_max_f32 v56, v56, v57
v_max_f32 v56, v56, v33
v_sub_f32 v57, v33, v56
v_exp_f32 v57, v57
v_mov_b32 v33, v56
v_accvgpr_read_b32 v59, a168
v_mul_f32 v59, v59, v57
v_accvgpr_write_b32 a168, v59
v_mul_f32 v96, v96, v57
v_mul_f32 v97, v97, v57
v_mul_f32 v98, v98, v57
v_mul_f32 v99, v99, v57
v_mul_f32 v100, v100, v57
v_mul_f32 v101, v101, v57
v_mul_f32 v102, v102, v57
v_mul_f32 v103, v103, v57
v_mul_f32 v104, v104, v57
v_mul_f32 v105, v105, v57
v_mul_f32 v106, v106, v57
v_mul_f32 v107, v107, v57
v_mul_f32 v108, v108, v57
v_mul_f32 v109, v109, v57
v_mul_f32 v110, v110, v57
v_mul_f32 v111, v111, v57
v_mul_f32 v112, v112, v57
v_mul_f32 v113, v113, v57
v_mul_f32 v114, v114, v57
v_mul_f32 v115, v115, v57
v_mul_f32 v116, v116, v57
v_mul_f32 v117, v117, v57
v_mul_f32 v118, v118, v57
v_mul_f32 v119, v119, v57
v_mul_f32 v120, v120, v57
v_mul_f32 v121, v121, v57
v_mul_f32 v122, v122, v57
v_mul_f32 v123, v123, v57
v_mul_f32 v124, v124, v57
v_mul_f32 v125, v125, v57
v_mul_f32 v126, v126, v57
v_mul_f32 v127, v127, v57
v_sub_f32 v16, v16, v56
v_sub_f32 v17, v17, v56
v_sub_f32 v18, v18, v56
v_sub_f32 v19, v19, v56
v_sub_f32 v20, v20, v56
v_sub_f32 v21, v21, v56
v_sub_f32 v22, v22, v56
v_sub_f32 v23, v23, v56
v_exp_f32 v16, v16
v_exp_f32 v17, v17
v_exp_f32 v18, v18
v_exp_f32 v19, v19
v_exp_f32 v20, v20
v_exp_f32 v21, v21
v_exp_f32 v22, v22
v_exp_f32 v23, v23
s_nop 0
v_cvt_pk_bf16_f32 v16, v16, v17
v_cvt_pk_bf16_f32 v17, v18, v19
v_cvt_pk_bf16_f32 v18, v20, v21
v_cvt_pk_bf16_f32 v19, v22, v23
s_nop 1
v_mfma_f32_16x16x32_bf16 a[168:171], a[160:163], v[16:19], a[168:171]
v_mfma_f32_16x16x32_bf16 v[96:99], a[128:131], v[16:19], v[96:99]
v_mfma_f32_16x16x32_bf16 v[100:103], a[132:135], v[16:19], v[100:103]
v_mfma_f32_16x16x32_bf16 v[104:107], a[136:139], v[16:19], v[104:107]
v_mfma_f32_16x16x32_bf16 v[108:111], a[140:143], v[16:19], v[108:111]
v_mfma_f32_16x16x32_bf16 v[112:115], a[144:147], v[16:19], v[112:115]
v_mfma_f32_16x16x32_bf16 v[116:119], a[148:151], v[16:19], v[116:119]
v_mfma_f32_16x16x32_bf16 v[120:123], a[152:155], v[16:19], v[120:123]
v_mfma_f32_16x16x32_bf16 v[124:127], a[156:159], v[16:19], v[124:127]
v_mfma_f32_16x16x32_bf16 v[24:27], a[96:99], a[32:35], 0
v_mfma_f32_16x16x32_bf16 v[24:27], a[100:103], a[36:39], v[24:27]
v_mfma_f32_16x16x32_bf16 v[24:27], a[104:107], a[40:43], v[24:27]
v_mfma_f32_16x16x32_bf16 v[24:27], a[108:111], a[44:47], v[24:27]
v_mfma_f32_16x16x32_bf16 v[28:31], a[112:115], a[32:35], 0
v_mfma_f32_16x16x32_bf16 v[28:31], a[116:119], a[36:39], v[28:31]
v_mfma_f32_16x16x32_bf16 v[28:31], a[120:123], a[40:43], v[28:31]
v_mfma_f32_16x16x32_bf16 v[28:31], a[124:127], a[44:47], v[28:31]
s_nop 7
v_max3_f32 v56, v24, v25, v26
v_max3_f32 v56, v56, v27, v28
v_max3_f32 v56, v56, v29, v30
v_max_f32 v56, v56, v31
v_mov_b32 v57, v56
s_nop 1
v_permlane16_swap_b32 v57, v56
s_nop 1
v_max_f32 v56, v56, v57
v_mov_b32 v57, v56
s_nop 1
v_permlane32_swap_b32 v57, v56
s_nop 1
v_max_f32 v56, v56, v57
v_max_f32 v56, v56, v34
v_sub_f32 v57, v34, v56
v_exp_f32 v57, v57
v_mov_b32 v34, v56
v_accvgpr_read_b32 v59, a172
v_mul_f32 v59, v59, v57
v_accvgpr_write_b32 a172, v59
v_mul_f32 v128, v128, v57
v_mul_f32 v129, v129, v57
v_mul_f32 v130, v130, v57
v_mul_f32 v131, v131, v57
v_mul_f32 v132, v132, v57
v_mul_f32 v133, v133, v57
v_mul_f32 v134, v134, v57
v_mul_f32 v135, v135, v57
v_mul_f32 v136, v136, v57
v_mul_f32 v137, v137, v57
v_mul_f32 v138, v138, v57
v_mul_f32 v139, v139, v57
v_mul_f32 v140, v140, v57
v_mul_f32 v141, v141, v57
v_mul_f32 v142, v142, v57
v_mul_f32 v143, v143, v57
v_mul_f32 v144, v144, v57
v_mul_f32 v145, v145, v57
v_mul_f32 v146, v146, v57
v_mul_f32 v147, v147, v57
v_mul_f32 v148, v148, v57
v_mul_f32 v149, v149, v57
v_mul_f32 v150, v150, v57
v_mul_f32 v151, v151, v57
v_mul_f32 v152, v152, v57
v_mul_f32 v153, v153, v57
v_mul_f32 v154, v154, v57
v_mul_f32 v155, v155, v57
v_mul_f32 v156, v156, v57
v_mul_f32 v157, v157, v57
v_mul_f32 v158, v158, v57
v_mul_f32 v159, v159, v57
v_sub_f32 v24, v24, v56
v_sub_f32 v25, v25, v56
v_sub_f32 v26, v26, v56
v_sub_f32 v27, v27, v56
v_sub_f32 v28, v28, v56
v_sub_f32 v29, v29, v56
v_sub_f32 v30, v30, v56
v_sub_f32 v31, v31, v56
v_exp_f32 v24, v24
v_exp_f32 v25, v25
v_exp_f32 v26, v26
v_exp_f32 v27, v27
v_exp_f32 v28, v28
v_exp_f32 v29, v29
v_exp_f32 v30, v30
v_exp_f32 v31, v31
s_nop 0
v_cvt_pk_bf16_f32 v24, v24, v25
v_cvt_pk_bf16_f32 v25, v26, v27
v_cvt_pk_bf16_f32 v26, v28, v29
v_cvt_pk_bf16_f32 v27, v30, v31
s_nop 1
v_mfma_f32_16x16x32_bf16 a[172:175], a[160:163], v[24:27], a[172:175]
v_mfma_f32_16x16x32_bf16 v[128:131], a[128:131], v[24:27], v[128:131]
v_mfma_f32_16x16x32_bf16 v[132:135], a[132:135], v[24:27], v[132:135]
v_mfma_f32_16x16x32_bf16 v[136:139], a[136:139], v[24:27], v[136:139]
v_mfma_f32_16x16x32_bf16 v[140:143], a[140:143], v[24:27], v[140:143]
v_mfma_f32_16x16x32_bf16 v[144:147], a[144:147], v[24:27], v[144:147]
v_mfma_f32_16x16x32_bf16 v[148:151], a[148:151], v[24:27], v[148:151]
v_mfma_f32_16x16x32_bf16 v[152:155], a[152:155], v[24:27], v[152:155]
v_mfma_f32_16x16x32_bf16 v[156:159], a[156:159], v[24:27], v[156:159]
v_mfma_f32_16x16x32_bf16 v[8:11], a[96:99], a[48:51], 0
v_mfma_f32_16x16x32_bf16 v[8:11], a[100:103], a[52:55], v[8:11]
v_mfma_f32_16x16x32_bf16 v[8:11], a[104:107], a[56:59], v[8:11]
v_mfma_f32_16x16x32_bf16 v[8:11], a[108:111], a[60:63], v[8:11]
v_mfma_f32_16x16x32_bf16 v[12:15], a[112:115], a[48:51], 0
v_mfma_f32_16x16x32_bf16 v[12:15], a[116:119], a[52:55], v[12:15]
v_mfma_f32_16x16x32_bf16 v[12:15], a[120:123], a[56:59], v[12:15]
v_mfma_f32_16x16x32_bf16 v[12:15], a[124:127], a[60:63], v[12:15]
s_nop 7
v_max3_f32 v56, v8, v9, v10
v_max3_f32 v56, v56, v11, v12
v_max3_f32 v56, v56, v13, v14
v_max_f32 v56, v56, v15
v_mov_b32 v57, v56
s_nop 1
v_permlane16_swap_b32 v57, v56
s_nop 1
v_max_f32 v56, v56, v57
v_mov_b32 v57, v56
s_nop 1
v_permlane32_swap_b32 v57, v56
s_nop 1
v_max_f32 v56, v56, v57
v_max_f32 v56, v56, v35
v_sub_f32 v57, v35, v56
v_exp_f32 v57, v57
v_mov_b32 v35, v56
v_accvgpr_read_b32 v59, a176
v_mul_f32 v59, v59, v57
v_accvgpr_write_b32 a176, v59
v_mul_f32 v160, v160, v57
v_mul_f32 v161, v161, v57
v_mul_f32 v162, v162, v57
v_mul_f32 v163, v163, v57
v_mul_f32 v164, v164, v57
v_mul_f32 v165, v165, v57
v_mul_f32 v166, v166, v57
v_mul_f32 v167, v167, v57
v_mul_f32 v168, v168, v57
v_mul_f32 v169, v169, v57
v_mul_f32 v170, v170, v57
v_mul_f32 v171, v171, v57
v_mul_f32 v172, v172, v57
v_mul_f32 v173, v173, v57
v_mul_f32 v174, v174, v57
v_mul_f32 v175, v175, v57
v_mul_f32 v176, v176, v57
v_mul_f32 v177, v177, v57
v_mul_f32 v178, v178, v57
v_mul_f32 v179, v179, v57
v_mul_f32 v180, v180, v57
v_mul_f32 v181, v181, v57
v_mul_f32 v182, v182, v57
v_mul_f32 v183, v183, v57
v_mul_f32 v184, v184, v57
v_mul_f32 v185, v185, v57
v_mul_f32 v186, v186, v57
v_mul_f32 v187, v187, v57
v_mul_f32 v188, v188, v57
v_mul_f32 v189, v189, v57
v_mul_f32 v190, v190, v57
v_mul_f32 v191, v191, v57
v_sub_f32 v8, v8, v56
v_sub_f32 v9, v9, v56
v_sub_f32 v10, v10, v56
v_sub_f32 v11, v11, v56
v_sub_f32 v12, v12, v56
v_sub_f32 v13, v13, v56
v_sub_f32 v14, v14, v56
v_sub_f32 v15, v15, v56
v_exp_f32 v8, v8
v_exp_f32 v9, v9
v_exp_f32 v10, v10
v_exp_f32 v11, v11
v_exp_f32 v12, v12
v_exp_f32 v13, v13
v_exp_f32 v14, v14
v_exp_f32 v15, v15
s_nop 0
v_cvt_pk_bf16_f32 v8, v8, v9
v_cvt_pk_bf16_f32 v9, v10, v11
v_cvt_pk_bf16_f32 v10, v12, v13
v_cvt_pk_bf16_f32 v11, v14, v15
s_nop 1
v_mfma_f32_16x16x32_bf16 a[176:179], a[160:163], v[8:11], a[176:179]
v_mfma_f32_16x16x32_bf16 v[160:163], a[128:131], v[8:11], v[160:163]
v_mfma_f32_16x16x32_bf16 v[164:167], a[132:135], v[8:11], v[164:167]
v_mfma_f32_16x16x32_bf16 v[168:171], a[136:139], v[8:11], v[168:171]
v_mfma_f32_16x16x32_bf16 v[172:175], a[140:143], v[8:11], v[172:175]
v_mfma_f32_16x16x32_bf16 v[176:179], a[144:147], v[8:11], v[176:179]
v_mfma_f32_16x16x32_bf16 v[180:183], a[148:151], v[8:11], v[180:183]
v_mfma_f32_16x16x32_bf16 v[184:187], a[152:155], v[8:11], v[184:187]
v_mfma_f32_16x16x32_bf16 v[188:191], a[156:159], v[8:11], v[188:191]
v_mfma_f32_16x16x32_bf16 v[16:19], a[96:99], a[64:67], 0
v_mfma_f32_16x16x32_bf16 v[16:19], a[100:103], a[68:71], v[16:19]
v_mfma_f32_16x16x32_bf16 v[16:19], a[104:107], a[72:75], v[16:19]
v_mfma_f32_16x16x32_bf16 v[16:19], a[108:111], a[76:79], v[16:19]
v_mfma_f32_16x16x32_bf16 v[20:23], a[112:115], a[64:67], 0
v_mfma_f32_16x16x32_bf16 v[20:23], a[116:119], a[68:71], v[20:23]
v_mfma_f32_16x16x32_bf16 v[20:23], a[120:123], a[72:75], v[20:23]
v_mfma_f32_16x16x32_bf16 v[20:23], a[124:127], a[76:79], v[20:23]
s_nop 7
v_max3_f32 v56, v16, v17, v18
v_max3_f32 v56, v56, v19, v20
v_max3_f32 v56, v56, v21, v22
v_max_f32 v56, v56, v23
v_mov_b32 v57, v56
s_nop 1
v_permlane16_swap_b32 v57, v56
s_nop 1
v_max_f32 v56, v56, v57
v_mov_b32 v57, v56
s_nop 1
v_permlane32_swap_b32 v57, v56
s_nop 1
v_max_f32 v56, v56, v57
v_max_f32 v56, v56, v36
v_sub_f32 v57, v36, v56
v_exp_f32 v57, v57
v_mov_b32 v36, v56
v_accvgpr_read_b32 v59, a180
v_mul_f32 v59, v59, v57
v_accvgpr_write_b32 a180, v59
v_mul_f32 v192, v192, v57
v_mul_f32 v193, v193, v57
v_mul_f32 v194, v194, v57
v_mul_f32 v195, v195, v57
v_mul_f32 v196, v196, v57
v_mul_f32 v197, v197, v57
v_mul_f32 v198, v198, v57
v_mul_f32 v199, v199, v57
v_mul_f32 v200, v200, v57
v_mul_f32 v201, v201, v57
v_mul_f32 v202, v202, v57
v_mul_f32 v203, v203, v57
v_mul_f32 v204, v204, v57
v_mul_f32 v205, v205, v57
v_mul_f32 v206, v206, v57
v_mul_f32 v207, v207, v57
v_mul_f32 v208, v208, v57
v_mul_f32 v209, v209, v57
v_mul_f32 v210, v210, v57
v_mul_f32 v211, v211, v57
v_mul_f32 v212, v212, v57
v_mul_f32 v213, v213, v57
v_mul_f32 v214, v214, v57
v_mul_f32 v215, v215, v57
v_mul_f32 v216, v216, v57
v_mul_f32 v217, v217, v57
v_mul_f32 v218, v218, v57
v_mul_f32 v219, v219, v57
v_mul_f32 v220, v220, v57
v_mul_f32 v221, v221, v57
v_mul_f32 v222, v222, v57
v_mul_f32 v223, v223, v57
v_sub_f32 v16, v16, v56
v_sub_f32 v17, v17, v56
v_sub_f32 v18, v18, v56
v_sub_f32 v19, v19, v56
v_sub_f32 v20, v20, v56
v_sub_f32 v21, v21, v56
v_sub_f32 v22, v22, v56
v_sub_f32 v23, v23, v56
v_exp_f32 v16, v16
v_exp_f32 v17, v17
v_exp_f32 v18, v18
v_exp_f32 v19, v19
v_exp_f32 v20, v20
v_exp_f32 v21, v21
v_exp_f32 v22, v22
v_exp_f32 v23, v23
s_nop 0
v_cvt_pk_bf16_f32 v16, v16, v17
v_cvt_pk_bf16_f32 v17, v18, v19
v_cvt_pk_bf16_f32 v18, v20, v21
v_cvt_pk_bf16_f32 v19, v22, v23
s_nop 1
v_mfma_f32_16x16x32_bf16 a[180:183], a[160:163], v[16:19], a[180:183]
v_mfma_f32_16x16x32_bf16 v[192:195], a[128:131], v[16:19], v[192:195]
v_mfma_f32_16x16x32_bf16 v[196:199], a[132:135], v[16:19], v[196:199]
v_mfma_f32_16x16x32_bf16 v[200:203], a[136:139], v[16:19], v[200:203]
v_mfma_f32_16x16x32_bf16 v[204:207], a[140:143], v[16:19], v[204:207]
v_mfma_f32_16x16x32_bf16 v[208:211], a[144:147], v[16:19], v[208:211]
v_mfma_f32_16x16x32_bf16 v[212:215], a[148:151], v[16:19], v[212:215]
v_mfma_f32_16x16x32_bf16 v[216:219], a[152:155], v[16:19], v[216:219]
v_mfma_f32_16x16x32_bf16 v[220:223], a[156:159], v[16:19], v[220:223]
v_mfma_f32_16x16x32_bf16 v[24:27], a[96:99], a[80:83], 0
v_mfma_f32_16x16x32_bf16 v[24:27], a[100:103], a[84:87], v[24:27]
v_mfma_f32_16x16x32_bf16 v[24:27], a[104:107], a[88:91], v[24:27]
v_mfma_f32_16x16x32_bf16 v[24:27], a[108:111], a[92:95], v[24:27]
v_mfma_f32_16x16x32_bf16 v[28:31], a[112:115], a[80:83], 0
v_mfma_f32_16x16x32_bf16 v[28:31], a[116:119], a[84:87], v[28:31]
v_mfma_f32_16x16x32_bf16 v[28:31], a[120:123], a[88:91], v[28:31]
v_mfma_f32_16x16x32_bf16 v[28:31], a[124:127], a[92:95], v[28:31]
s_nop 7
v_max3_f32 v56, v24, v25, v26
v_max3_f32 v56, v56, v27, v28
v_max3_f32 v56, v56, v29, v30
v_max_f32 v56, v56, v31
v_mov_b32 v57, v56
s_nop 1
v_permlane16_swap_b32 v57, v56
s_nop 1
v_max_f32 v56, v56, v57
v_mov_b32 v57, v56
s_nop 1
v_permlane32_swap_b32 v57, v56
s_nop 1
v_max_f32 v56, v56, v57
v_max_f32 v56, v56, v37
v_sub_f32 v57, v37, v56
v_exp_f32 v57, v57
v_mov_b32 v37, v56
v_accvgpr_read_b32 v59, a184
v_mul_f32 v59, v59, v57
v_accvgpr_write_b32 a184, v59
v_mul_f32 v224, v224, v57
v_mul_f32 v225, v225, v57
v_mul_f32 v226, v226, v57
v_mul_f32 v227, v227, v57
v_mul_f32 v228, v228, v57
v_mul_f32 v229, v229, v57
v_mul_f32 v230, v230, v57
v_mul_f32 v231, v231, v57
v_mul_f32 v232, v232, v57
v_mul_f32 v233, v233, v57
v_mul_f32 v234, v234, v57
v_mul_f32 v235, v235, v57
v_mul_f32 v236, v236, v57
v_mul_f32 v237, v237, v57
v_mul_f32 v238, v238, v57
v_mul_f32 v239, v239, v57
v_mul_f32 v240, v240, v57
v_mul_f32 v241, v241, v57
v_mul_f32 v242, v242, v57
v_mul_f32 v243, v243, v57
v_mul_f32 v244, v244, v57
v_mul_f32 v245, v245, v57
v_mul_f32 v246, v246, v57
v_mul_f32 v247, v247, v57
v_mul_f32 v248, v248, v57
v_mul_f32 v249, v249, v57
v_mul_f32 v250, v250, v57
v_mul_f32 v251, v251, v57
v_mul_f32 v252, v252, v57
v_mul_f32 v253, v253, v57
v_mul_f32 v254, v254, v57
v_mul_f32 v255, v255, v57
v_sub_f32 v24, v24, v56
v_sub_f32 v25, v25, v56
v_sub_f32 v26, v26, v56
v_sub_f32 v27, v27, v56
v_sub_f32 v28, v28, v56
v_sub_f32 v29, v29, v56
v_sub_f32 v30, v30, v56
v_sub_f32 v31, v31, v56
v_exp_f32 v24, v24
v_exp_f32 v25, v25
v_exp_f32 v26, v26
v_exp_f32 v27, v27
v_exp_f32 v28, v28
v_exp_f32 v29, v29
v_exp_f32 v30, v30
v_exp_f32 v31, v31
s_nop 0
v_cvt_pk_bf16_f32 v24, v24, v25
v_cvt_pk_bf16_f32 v25, v26, v27
v_cvt_pk_bf16_f32 v26, v28, v29
v_cvt_pk_bf16_f32 v27, v30, v31
s_nop 1
v_mfma_f32_16x16x32_bf16 a[184:187], a[160:163], v[24:27], a[184:187]
v_mfma_f32_16x16x32_bf16 v[224:227], a[128:131], v[24:27], v[224:227]
v_mfma_f32_16x16x32_bf16 v[228:231], a[132:135], v[24:27], v[228:231]
v_mfma_f32_16x16x32_bf16 v[232:235], a[136:139], v[24:27], v[232:235]
v_mfma_f32_16x16x32_bf16 v[236:239], a[140:143], v[24:27], v[236:239]
v_mfma_f32_16x16x32_bf16 v[240:243], a[144:147], v[24:27], v[240:243]
v_mfma_f32_16x16x32_bf16 v[244:247], a[148:151], v[24:27], v[244:247]
v_mfma_f32_16x16x32_bf16 v[248:251], a[152:155], v[24:27], v[248:251]
v_mfma_f32_16x16x32_bf16 v[252:255], a[156:159], v[24:27], v[252:255]
v_add_u32 v3, 0x2000, v3
s_add_u32 s44, s44, 1
s_cmp_lt_u32 s44, 32
s_cbranch_scc1 L_fb_loop
v_lshlrev_b32 v3, 4, v0
s_nop 7
ds_bpermute_b32 a165, v58, a164
s_waitcnt lgkmcnt(0)
v_accvgpr_read_b32 v6, a165
v_rcp_f32 v6, v6
s_nop 0
v_mov_b32 v7, v6
v_pk_mul_f32 v[64:65], v[64:65], v[6:7]
v_pk_mul_f32 v[66:67], v[66:67], v[6:7]
v_cvt_pk_bf16_f32 v64, v64, v65
v_cvt_pk_bf16_f32 v65, v66, v67
ds_write_b64 v4, v[64:65] offset:0
v_pk_mul_f32 v[68:69], v[68:69], v[6:7]
v_pk_mul_f32 v[70:71], v[70:71], v[6:7]
v_cvt_pk_bf16_f32 v68, v68, v69
v_cvt_pk_bf16_f32 v69, v70, v71
ds_write_b64 v4, v[68:69] offset:32
v_pk_mul_f32 v[72:73], v[72:73], v[6:7]
v_pk_mul_f32 v[74:75], v[74:75], v[6:7]
v_cvt_pk_bf16_f32 v72, v72, v73
v_cvt_pk_bf16_f32 v73, v74, v75
ds_write_b64 v4, v[72:73] offset:64
v_pk_mul_f32 v[76:77], v[76:77], v[6:7]
v_pk_mul_f32 v[78:79], v[78:79], v[6:7]
v_cvt_pk_bf16_f32 v76, v76, v77
v_cvt_pk_bf16_f32 v77, v78, v79
ds_write_b64 v4, v[76:77] offset:96
v_pk_mul_f32 v[80:81], v[80:81], v[6:7]
v_pk_mul_f32 v[82:83], v[82:83], v[6:7]
v_cvt_pk_bf16_f32 v80, v80, v81
v_cvt_pk_bf16_f32 v81, v82, v83
ds_write_b64 v4, v[80:81] offset:128
v_pk_mul_f32 v[84:85], v[84:85], v[6:7]
v_pk_mul_f32 v[86:87], v[86:87], v[6:7]
v_cvt_pk_bf16_f32 v84, v84, v85
v_cvt_pk_bf16_f32 v85, v86, v87
ds_write_b64 v4, v[84:85] offset:160
v_pk_mul_f32 v[88:89], v[88:89], v[6:7]
v_pk_mul_f32 v[90:91], v[90:91], v[6:7]
v_cvt_pk_bf16_f32 v88, v88, v89
v_cvt_pk_bf16_f32 v89, v90, v91
ds_write_b64 v4, v[88:89] offset:192
v_pk_mul_f32 v[92:93], v[92:93], v[6:7]
v_pk_mul_f32 v[94:95], v[94:95], v[6:7]
v_cvt_pk_bf16_f32 v92, v92, v93
v_cvt_pk_bf16_f32 v93, v94, v95
ds_write_b64 v4, v[92:93] offset:224
ds_read_b128 v[64:67], v5 offset:0
ds_read_b128 v[68:71], v5 offset:1088
ds_read_b128 v[72:75], v5 offset:2176
ds_read_b128 v[76:79], v5 offset:3264
s_waitcnt lgkmcnt(0)
buffer_store_dwordx4 v[64:67], v3, s[24:27], 0 offen offset:0 nt
buffer_store_dwordx4 v[68:71], v3, s[24:27], 0 offen offset:1024 nt
buffer_store_dwordx4 v[72:75], v3, s[24:27], 0 offen offset:2048 nt
buffer_store_dwordx4 v[76:79], v3, s[24:27], 0 offen offset:3072 nt
ds_bpermute_b32 a169, v58, a168
s_waitcnt lgkmcnt(0)
v_accvgpr_read_b32 v6, a169
v_rcp_f32 v6, v6
s_nop 0
v_mov_b32 v7, v6
v_pk_mul_f32 v[96:97], v[96:97], v[6:7]
v_pk_mul_f32 v[98:99], v[98:99], v[6:7]
v_cvt_pk_bf16_f32 v96, v96, v97
v_cvt_pk_bf16_f32 v97, v98, v99
ds_write_b64 v4, v[96:97] offset:4352
v_pk_mul_f32 v[100:101], v[100:101], v[6:7]
v_pk_mul_f32 v[102:103], v[102:103], v[6:7]
v_cvt_pk_bf16_f32 v100, v100, v101
v_cvt_pk_bf16_f32 v101, v102, v103
ds_write_b64 v4, v[100:101] offset:4384
v_pk_mul_f32 v[104:105], v[104:105], v[6:7]
v_pk_mul_f32 v[106:107], v[106:107], v[6:7]
v_cvt_pk_bf16_f32 v104, v104, v105
v_cvt_pk_bf16_f32 v105, v106, v107
ds_write_b64 v4, v[104:105] offset:4416
v_pk_mul_f32 v[108:109], v[108:109], v[6:7]
v_pk_mul_f32 v[110:111], v[110:111], v[6:7]
v_cvt_pk_bf16_f32 v108, v108, v109
v_cvt_pk_bf16_f32 v109, v110, v111
ds_write_b64 v4, v[108:109] offset:4448
v_pk_mul_f32 v[112:113], v[112:113], v[6:7]
v_pk_mul_f32 v[114:115], v[114:115], v[6:7]
v_cvt_pk_bf16_f32 v112, v112, v113
v_cvt_pk_bf16_f32 v113, v114, v115
ds_write_b64 v4, v[112:113] offset:4480
v_pk_mul_f32 v[116:117], v[116:117], v[6:7]
v_pk_mul_f32 v[118:119], v[118:119], v[6:7]
v_cvt_pk_bf16_f32 v116, v116, v117
v_cvt_pk_bf16_f32 v117, v118, v119
ds_write_b64 v4, v[116:117] offset:4512
v_pk_mul_f32 v[120:121], v[120:121], v[6:7]
v_pk_mul_f32 v[122:123], v[122:123], v[6:7]
v_cvt_pk_bf16_f32 v120, v120, v121
v_cvt_pk_bf16_f32 v121, v122, v123
ds_write_b64 v4, v[120:121] offset:4544
v_pk_mul_f32 v[124:125], v[124:125], v[6:7]
v_pk_mul_f32 v[126:127], v[126:127], v[6:7]
v_cvt_pk_bf16_f32 v124, v124, v125
v_cvt_pk_bf16_f32 v125, v126, v127
ds_write_b64 v4, v[124:125] offset:4576
ds_read_b128 v[96:99], v5 offset:4352
ds_read_b128 v[100:103], v5 offset:5440
ds_read_b128 v[104:107], v5 offset:6528
ds_read_b128 v[108:111], v5 offset:7616
s_waitcnt lgkmcnt(0)
buffer_store_dwordx4 v[96:99], v3, s[24:27], s84 offen offset:0 nt
buffer_store_dwordx4 v[100:103], v3, s[24:27], s84 offen offset:1024 nt
buffer_store_dwordx4 v[104:107], v3, s[24:27], s84 offen offset:2048 nt
buffer_store_dwordx4 v[108:111], v3, s[24:27], s84 offen offset:3072 nt
ds_bpermute_b32 a173, v58, a172
s_waitcnt lgkmcnt(0)
v_accvgpr_read_b32 v6, a173
v_rcp_f32 v6, v6
s_nop 0
v_mov_b32 v7, v6
v_pk_mul_f32 v[128:129], v[128:129], v[6:7]
v_pk_mul_f32 v[130:131], v[130:131], v[6:7]
v_cvt_pk_bf16_f32 v128, v128, v129
v_cvt_pk_bf16_f32 v129, v130, v131
ds_write_b64 v4, v[128:129] offset:8704
v_pk_mul_f32 v[132:133], v[132:133], v[6:7]
v_pk_mul_f32 v[134:135], v[134:135], v[6:7]
v_cvt_pk_bf16_f32 v132, v132, v133
v_cvt_pk_bf16_f32 v133, v134, v135
ds_write_b64 v4, v[132:133] offset:8736
v_pk_mul_f32 v[136:137], v[136:137], v[6:7]
v_pk_mul_f32 v[138:139], v[138:139], v[6:7]
v_cvt_pk_bf16_f32 v136, v136, v137
v_cvt_pk_bf16_f32 v137, v138, v139
ds_write_b64 v4, v[136:137] offset:8768
v_pk_mul_f32 v[140:141], v[140:141], v[6:7]
v_pk_mul_f32 v[142:143], v[142:143], v[6:7]
v_cvt_pk_bf16_f32 v140, v140, v141
v_cvt_pk_bf16_f32 v141, v142, v143
ds_write_b64 v4, v[140:141] offset:8800
v_pk_mul_f32 v[144:145], v[144:145], v[6:7]
v_pk_mul_f32 v[146:147], v[146:147], v[6:7]
v_cvt_pk_bf16_f32 v144, v144, v145
v_cvt_pk_bf16_f32 v145, v146, v147
ds_write_b64 v4, v[144:145] offset:8832
v_pk_mul_f32 v[148:149], v[148:149], v[6:7]
v_pk_mul_f32 v[150:151], v[150:151], v[6:7]
v_cvt_pk_bf16_f32 v148, v148, v149
v_cvt_pk_bf16_f32 v149, v150, v151
ds_write_b64 v4, v[148:149] offset:8864
v_pk_mul_f32 v[152:153], v[152:153], v[6:7]
v_pk_mul_f32 v[154:155], v[154:155], v[6:7]
v_cvt_pk_bf16_f32 v152, v152, v153
v_cvt_pk_bf16_f32 v153, v154, v155
ds_write_b64 v4, v[152:153] offset:8896
v_pk_mul_f32 v[156:157], v[156:157], v[6:7]
v_pk_mul_f32 v[158:159], v[158:159], v[6:7]
v_cvt_pk_bf16_f32 v156, v156, v157
v_cvt_pk_bf16_f32 v157, v158, v159
ds_write_b64 v4, v[156:157] offset:8928
ds_read_b128 v[128:131], v5 offset:8704
ds_read_b128 v[132:135], v5 offset:9792
ds_read_b128 v[136:139], v5 offset:10880
ds_read_b128 v[140:143], v5 offset:11968
s_waitcnt lgkmcnt(0)
buffer_store_dwordx4 v[128:131], v3, s[24:27], s85 offen offset:0 nt
buffer_store_dwordx4 v[132:135], v3, s[24:27], s85 offen offset:1024 nt
buffer_store_dwordx4 v[136:139], v3, s[24:27], s85 offen offset:2048 nt
buffer_store_dwordx4 v[140:143], v3, s[24:27], s85 offen offset:3072 nt
ds_bpermute_b32 a177, v58, a176
s_waitcnt lgkmcnt(0)
v_accvgpr_read_b32 v6, a177
v_rcp_f32 v6, v6
s_nop 0
v_mov_b32 v7, v6
v_pk_mul_f32 v[160:161], v[160:161], v[6:7]
v_pk_mul_f32 v[162:163], v[162:163], v[6:7]
v_cvt_pk_bf16_f32 v160, v160, v161
v_cvt_pk_bf16_f32 v161, v162, v163
ds_write_b64 v4, v[160:161] offset:0
v_pk_mul_f32 v[164:165], v[164:165], v[6:7]
v_pk_mul_f32 v[166:167], v[166:167], v[6:7]
v_cvt_pk_bf16_f32 v164, v164, v165
v_cvt_pk_bf16_f32 v165, v166, v167
ds_write_b64 v4, v[164:165] offset:32
v_pk_mul_f32 v[168:169], v[168:169], v[6:7]
v_pk_mul_f32 v[170:171], v[170:171], v[6:7]
v_cvt_pk_bf16_f32 v168, v168, v169
v_cvt_pk_bf16_f32 v169, v170, v171
ds_write_b64 v4, v[168:169] offset:64
v_pk_mul_f32 v[172:173], v[172:173], v[6:7]
v_pk_mul_f32 v[174:175], v[174:175], v[6:7]
v_cvt_pk_bf16_f32 v172, v172, v173
v_cvt_pk_bf16_f32 v173, v174, v175
ds_write_b64 v4, v[172:173] offset:96
v_pk_mul_f32 v[176:177], v[176:177], v[6:7]
v_pk_mul_f32 v[178:179], v[178:179], v[6:7]
v_cvt_pk_bf16_f32 v176, v176, v177
v_cvt_pk_bf16_f32 v177, v178, v179
ds_write_b64 v4, v[176:177] offset:128
v_pk_mul_f32 v[180:181], v[180:181], v[6:7]
v_pk_mul_f32 v[182:183], v[182:183], v[6:7]
v_cvt_pk_bf16_f32 v180, v180, v181
v_cvt_pk_bf16_f32 v181, v182, v183
ds_write_b64 v4, v[180:181] offset:160
v_pk_mul_f32 v[184:185], v[184:185], v[6:7]
v_pk_mul_f32 v[186:187], v[186:187], v[6:7]
v_cvt_pk_bf16_f32 v184, v184, v185
v_cvt_pk_bf16_f32 v185, v186, v187
ds_write_b64 v4, v[184:185] offset:192
v_pk_mul_f32 v[188:189], v[188:189], v[6:7]
v_pk_mul_f32 v[190:191], v[190:191], v[6:7]
v_cvt_pk_bf16_f32 v188, v188, v189
v_cvt_pk_bf16_f32 v189, v190, v191
ds_write_b64 v4, v[188:189] offset:224
ds_read_b128 v[160:163], v5 offset:0
ds_read_b128 v[164:167], v5 offset:1088
ds_read_b128 v[168:171], v5 offset:2176
ds_read_b128 v[172:175], v5 offset:3264
s_waitcnt lgkmcnt(0)
buffer_store_dwordx4 v[160:163], v3, s[24:27], s86 offen offset:0 nt
buffer_store_dwordx4 v[164:167], v3, s[24:27], s86 offen offset:1024 nt
buffer_store_dwordx4 v[168:171], v3, s[24:27], s86 offen offset:2048 nt
buffer_store_dwordx4 v[172:175], v3, s[24:27], s86 offen offset:3072 nt
ds_bpermute_b32 a181, v58, a180
s_waitcnt lgkmcnt(0)
v_accvgpr_read_b32 v6, a181
v_rcp_f32 v6, v6
s_nop 0
v_mov_b32 v7, v6
v_pk_mul_f32 v[192:193], v[192:193], v[6:7]
v_pk_mul_f32 v[194:195], v[194:195], v[6:7]
v_cvt_pk_bf16_f32 v192, v192, v193
v_cvt_pk_bf16_f32 v193, v194, v195
ds_write_b64 v4, v[192:193] offset:4352
v_pk_mul_f32 v[196:197], v[196:197], v[6:7]
v_pk_mul_f32 v[198:199], v[198:199], v[6:7]
v_cvt_pk_bf16_f32 v196, v196, v197
v_cvt_pk_bf16_f32 v197, v198, v199
ds_write_b64 v4, v[196:197] offset:4384
v_pk_mul_f32 v[200:201], v[200:201], v[6:7]
v_pk_mul_f32 v[202:203], v[202:203], v[6:7]
v_cvt_pk_bf16_f32 v200, v200, v201
v_cvt_pk_bf16_f32 v201, v202, v203
ds_write_b64 v4, v[200:201] offset:4416
v_pk_mul_f32 v[204:205], v[204:205], v[6:7]
v_pk_mul_f32 v[206:207], v[206:207], v[6:7]
v_cvt_pk_bf16_f32 v204, v204, v205
v_cvt_pk_bf16_f32 v205, v206, v207
ds_write_b64 v4, v[204:205] offset:4448
v_pk_mul_f32 v[208:209], v[208:209], v[6:7]
v_pk_mul_f32 v[210:211], v[210:211], v[6:7]
v_cvt_pk_bf16_f32 v208, v208, v209
v_cvt_pk_bf16_f32 v209, v210, v211
ds_write_b64 v4, v[208:209] offset:4480
v_pk_mul_f32 v[212:213], v[212:213], v[6:7]
v_pk_mul_f32 v[214:215], v[214:215], v[6:7]
v_cvt_pk_bf16_f32 v212, v212, v213
v_cvt_pk_bf16_f32 v213, v214, v215
ds_write_b64 v4, v[212:213] offset:4512
v_pk_mul_f32 v[216:217], v[216:217], v[6:7]
v_pk_mul_f32 v[218:219], v[218:219], v[6:7]
v_cvt_pk_bf16_f32 v216, v216, v217
v_cvt_pk_bf16_f32 v217, v218, v219
ds_write_b64 v4, v[216:217] offset:4544
v_pk_mul_f32 v[220:221], v[220:221], v[6:7]
v_pk_mul_f32 v[222:223], v[222:223], v[6:7]
v_cvt_pk_bf16_f32 v220, v220, v221
v_cvt_pk_bf16_f32 v221, v222, v223
ds_write_b64 v4, v[220:221] offset:4576
ds_read_b128 v[192:195], v5 offset:4352
ds_read_b128 v[196:199], v5 offset:5440
ds_read_b128 v[200:203], v5 offset:6528
ds_read_b128 v[204:207], v5 offset:7616
s_waitcnt lgkmcnt(0)
buffer_store_dwordx4 v[192:195], v3, s[24:27], s87 offen offset:0 nt
buffer_store_dwordx4 v[196:199], v3, s[24:27], s87 offen offset:1024 nt
buffer_store_dwordx4 v[200:203], v3, s[24:27], s87 offen offset:2048 nt
buffer_store_dwordx4 v[204:207], v3, s[24:27], s87 offen offset:3072 nt
ds_bpermute_b32 a185, v58, a184
s_waitcnt lgkmcnt(0)
v_accvgpr_read_b32 v6, a185
v_rcp_f32 v6, v6
s_nop 0
v_mov_b32 v7, v6
v_pk_mul_f32 v[224:225], v[224:225], v[6:7]
v_pk_mul_f32 v[226:227], v[226:227], v[6:7]
v_cvt_pk_bf16_f32 v224, v224, v225
v_cvt_pk_bf16_f32 v225, v226, v227
ds_write_b64 v4, v[224:225] offset:8704
v_pk_mul_f32 v[228:229], v[228:229], v[6:7]
v_pk_mul_f32 v[230:231], v[230:231], v[6:7]
v_cvt_pk_bf16_f32 v228, v228, v229
v_cvt_pk_bf16_f32 v229, v230, v231
ds_write_b64 v4, v[228:229] offset:8736
v_pk_mul_f32 v[232:233], v[232:233], v[6:7]
v_pk_mul_f32 v[234:235], v[234:235], v[6:7]
v_cvt_pk_bf16_f32 v232, v232, v233
v_cvt_pk_bf16_f32 v233, v234, v235
ds_write_b64 v4, v[232:233] offset:8768
v_pk_mul_f32 v[236:237], v[236:237], v[6:7]
v_pk_mul_f32 v[238:239], v[238:239], v[6:7]
v_cvt_pk_bf16_f32 v236, v236, v237
v_cvt_pk_bf16_f32 v237, v238, v239
ds_write_b64 v4, v[236:237] offset:8800
v_pk_mul_f32 v[240:241], v[240:241], v[6:7]
v_pk_mul_f32 v[242:243], v[242:243], v[6:7]
v_cvt_pk_bf16_f32 v240, v240, v241
v_cvt_pk_bf16_f32 v241, v242, v243
ds_write_b64 v4, v[240:241] offset:8832
v_pk_mul_f32 v[244:245], v[244:245], v[6:7]
v_pk_mul_f32 v[246:247], v[246:247], v[6:7]
v_cvt_pk_bf16_f32 v244, v244, v245
v_cvt_pk_bf16_f32 v245, v246, v247
ds_write_b64 v4, v[244:245] offset:8864
v_pk_mul_f32 v[248:249], v[248:249], v[6:7]
v_pk_mul_f32 v[250:251], v[250:251], v[6:7]
v_cvt_pk_bf16_f32 v248, v248, v249
v_cvt_pk_bf16_f32 v249, v250, v251
ds_write_b64 v4, v[248:249] offset:8896
v_pk_mul_f32 v[252:253], v[252:253], v[6:7]
v_pk_mul_f32 v[254:255], v[254:255], v[6:7]
v_cvt_pk_bf16_f32 v252, v252, v253
v_cvt_pk_bf16_f32 v253, v254, v255
ds_write_b64 v4, v[252:253] offset:8928
ds_read_b128 v[224:227], v5 offset:8704
ds_read_b128 v[228:231], v5 offset:9792
ds_read_b128 v[232:235], v5 offset:10880
ds_read_b128 v[236:239], v5 offset:11968
s_waitcnt lgkmcnt(0)
buffer_store_dwordx4 v[224:227], v3, s[24:27], s88 offen offset:0 nt
buffer_store_dwordx4 v[228:231], v3, s[24:27], s88 offen offset:1024 nt
buffer_store_dwordx4 v[232:235], v3, s[24:27], s88 offen offset:2048 nt
buffer_store_dwordx4 v[236:239], v3, s[24:27], s88 offen offset:3072 nt
s_branch L_done
.section .rodata,"a"
.p2align 6
.amdhsa_kernel standalone__mha_softmax__near_ridge_kernel
  .amdhsa_next_free_vgpr 444
  .amdhsa_next_free_sgpr 96
  .amdhsa_accum_offset 256
  .amdhsa_group_segment_fixed_size 0
  .amdhsa_kernarg_size 48
  .amdhsa_user_sgpr_count 2
  .amdhsa_user_sgpr_kernarg_segment_ptr 1
  .amdhsa_system_sgpr_workgroup_id_x 1
  .amdhsa_float_denorm_mode_32 3
.end_amdhsa_kernel
```
